```python
import torch

def _softmax(x, axis=-1):
    return torch.softmax(x, dim=axis)
def _gelu(x):
    return torch.nn.functional.gelu(x, approximate="tanh")
def _silu(x):
    return torch.nn.functional.silu(x)
def _sigmoid(x):
    return torch.sigmoid(x)
def _layernorm(x, axis=-1, eps=1e-5):
    m = x.mean(dim=axis, keepdim=True)
    v = x.var(dim=axis, keepdim=True, unbiased=False)
    return (x - m) / torch.sqrt(v + eps)
def _scatter_add(tgt, idx, src, axis=0):
    return tgt.clone().index_add_(axis, idx, src)
def _segment_sum(src, seg, n):
    out = torch.zeros((n,) + src.shape[1:], dtype=src.dtype)
    return out.index_add_(0, seg, src)
def _pad(x, pw):
    flat = tuple(v for pair in reversed(pw) for v in pair)
    return torch.nn.functional.pad(x, flat)

kernel_name = 'concat_heads__sliding_block_cached__gqa_block_cached__decode'

def setup_inputs():

    _w = (lambda a: (lambda t: t.to(torch.bfloat16) if t.is_floating_point() else t)(torch.as_tensor(a)))
    def _A_setup():
        B, Sq, D = 2, 1, 512
        Hq, Hkv, Sk, Dh = 32, 8, 8192, 128
        assert Hq % Hkv == 0, (Hq, Hkv)
        return {
            "x": _w((lambda *s: torch.randn(*s, dtype=torch.bfloat16) * 0.2)(B, Sq, D)),
            "k_cache": _w((lambda *s: torch.randn(*s, dtype=torch.bfloat16) * 3.2)(B, Hkv, Sk, Dh)),
            "v_cache": _w((lambda *s: torch.randn(*s, dtype=torch.bfloat16) * 1.6)(B, Hkv, Sk, Dh)),
            "wq": _w((lambda *s: torch.randn(*s, dtype=torch.bfloat16) * 3.2)(D, Hq * Dh) * (D ** -0.5)),
            "wo": _w((lambda *s: torch.randn(*s, dtype=torch.bfloat16) * 1.6)(Hq * Dh, D) * ((Hq * Dh) ** -0.5)),
        }
    _A_in = _A_setup()

    def _B_setup():
        B, Sq, D = 2, 1, 512
        Hq, Hkv, Sk, Dh = 32, 8, 8192, 128
        assert Hq % Hkv == 0, (Hq, Hkv)
        return {
            "x": _w((lambda *s: torch.randn(*s, dtype=torch.bfloat16) * 0.4)(B, Sq, D)),
            "k_cache": _w((lambda *s: torch.randn(*s, dtype=torch.bfloat16) * 3.2)(B, Hkv, Sk, Dh)),
            "v_cache": _w((lambda *s: torch.randn(*s, dtype=torch.bfloat16) * 0.8)(B, Hkv, Sk, Dh)),
            "wq": _w((lambda *s: torch.randn(*s, dtype=torch.bfloat16) * 3.2)(D, Hq * Dh) * (D ** -0.5)),
            "wo": _w((lambda *s: torch.randn(*s, dtype=torch.bfloat16) * 0.8)(Hq * Dh, D) * ((Hq * Dh) ** -0.5)),
        }
    _B_in = _B_setup()

    return {
        "A_x": _A_in["x"],
        "A_k_cache": _A_in["k_cache"],
        "A_v_cache": _A_in["v_cache"],
        "A_wq": _A_in["wq"],
        "A_wo": _A_in["wo"],
        "B_x": _B_in["x"],
        "B_k_cache": _B_in["k_cache"],
        "B_v_cache": _B_in["v_cache"],
        "B_wq": _B_in["wq"],
        "B_wo": _B_in["wo"],
    }

def reference(A_x, A_k_cache, A_v_cache, A_wq, A_wo, B_x, B_k_cache, B_v_cache, B_wq, B_wo):
    def _A_ref(x, k_cache, v_cache, wq, wo):
        B, Sq, D = x.shape
        Hq, Dh = 32, 128
        Hkv, Sk = k_cache.shape[1], k_cache.shape[2]
        W = min(4096, max(256, Sk // 4))
        rep = Hq // Hkv
        q = (lambda x, *d: x.permute(*d))((x @ wq).reshape(B, Sq, Hq, Dh), 0, 2, 1, 3)
        k = (lambda x, n, axis: torch.repeat_interleave(x, n, dim=axis))(k_cache[:, :, Sk - W:, :], rep, axis=1)
        v = (lambda x, n, axis: torch.repeat_interleave(x, n, dim=axis))(v_cache[:, :, Sk - W:, :], rep, axis=1)
        scores = torch.einsum("bhqd,bhkd->bhqk", q, k) * (Dh ** -0.5)
        p = _softmax(scores, axis=-1)
        o = torch.einsum("bhqk,bhkd->bhqd", p, v)
        return (lambda x, *d: x.permute(*d))(o, 0, 2, 1, 3).reshape(B, Sq, Hq * Dh) @ wo

    def _B_ref(x, k_cache, v_cache, wq, wo):
        B, Sq, D = x.shape
        Hq, Dh = 32, 128
        Hkv = k_cache.shape[1]
        rep = Hq // Hkv
        q = (lambda x, *d: x.permute(*d))((x @ wq).reshape(B, Sq, Hq, Dh), 0, 2, 1, 3)
        k = (lambda x, n, axis: torch.repeat_interleave(x, n, dim=axis))(k_cache, rep, axis=1)
        v = (lambda x, n, axis: torch.repeat_interleave(x, n, dim=axis))(v_cache, rep, axis=1)
        scores = torch.einsum("bhqd,bhkd->bhqk", q, k) * (Dh ** -0.5)
        p = _softmax(scores, axis=-1)
        o = torch.einsum("bhqk,bhkd->bhqd", p, v)
        return (lambda x, *d: x.permute(*d))(o, 0, 2, 1, 3).reshape(B, Sq, Hq * Dh) @ wo

    a = _A_ref(A_x, A_k_cache, A_v_cache, A_wq, A_wo)
    b = _B_ref(B_x, B_k_cache, B_v_cache, B_wq, B_wo)
    return torch.concatenate([a, b], axis=-1)
```

```asm
; @launch grid=(256,1,1) block=(256,1,1) lds=24576
.amdgcn_target "amdgcn-amd-amdhsa--gfx950"
.text
.globl concat_heads__sliding_block_cached__gqa_block_cached__decode_kernel
.p2align 8
.type concat_heads__sliding_block_cached__gqa_block_cached__decode_kernel,@function
concat_heads__sliding_block_cached__gqa_block_cached__decode_kernel:
    s_cmp_ge_u32 s2, 256
    s_cbranch_scc1 L_end
    s_load_dwordx16 s[4:19], s[0:1], 0
    s_load_dwordx4 s[20:23], s[0:1], 64
    s_load_dwordx2 s[24:25], s[0:1], 80
    s_load_dwordx2 s[26:27], s[0:1], 96
    s_setprio 3
    v_lshrrev_b32 v7, 6, v0
    v_and_b32 v1, 63, v0
    v_readfirstlane_b32 s64, v7
    s_and_b32 s65, s2, 7
    s_lshr_b32 s66, s2, 3
    s_lshr_b32 s67, s66, 4
    s_and_b32 s68, s66, 15
    s_mov_b32 s78, s67
    s_mov_b32 s79, s65
    v_lshrrev_b32 v7, 4, v1
    v_lshrrev_b32 v9, 3, v1
    v_lshlrev_b32 v6, 16, v9
    v_and_b32 v9, 7, v1
    v_lshl_add_u32 v6, v9, 4, v6
    v_bfe_u32 v9, v1, 2, 1
    v_lshlrev_b32 v10, 10, v9
    v_lshl_add_u32 v10, v7, 5, v10
    v_and_b32 v9, 1, v1
    v_lshl_add_u32 v10, v9, 4, v10
    v_bfe_u32 v9, v1, 2, 2
    v_lshlrev_b32 v2, 8, v9
    v_lshl_add_u32 v2, v7, 6, v2
    v_and_b32 v9, 3, v1
    v_lshl_add_u32 v2, v9, 4, v2
    v_add_u32 v3, 4096, v2
    s_and_b32 s74, s66, 1
    s_lshl_b32 s74, s74, 2
    s_add_u32 s74, s74, s64
    s_lshl_b32 s76, s74, 7
    s_lshl_b32 s72, s74, 19
    s_lshl_b32 s75, s65, 10
    s_add_u32 s72, s72, s75
    s_bfe_u32 s75, s66, 0x30001
    s_lshl_b32 s75, s75, 7
    s_add_u32 s72, s72, s75
    s_lshl_b32 s74, s78, 3
    s_add_u32 s74, s74, s79
    s_lshl_b32 s71, s74, 21
    s_lshl_b32 s99, s74, 8
    s_add_u32 s99, s99, 4096
    s_lshl_b32 s75, s64, 13
    s_add_u32 s77, s71, s75
    s_lshl_b32 s75, s68, 15
    s_add_u32 s70, s77, s75
    s_add_u32 s70, s70, 0x180000
    s_mul_i32 s75, s68, 131072
    s_add_u32 s3, s77, s75
    s_mov_b32 s31, 0x20000
    s_mov_b32 s35, 0x20000
    s_mov_b32 s39, 0x20000
    s_mov_b32 s43, 0x20000
    s_mov_b32 s47, 0x20000
    s_mov_b32 s51, 0x20000
    s_mov_b32 s55, 0x20000
    s_mov_b32 s59, 0x20000
    s_mov_b32 s63, 0x20000
    s_mov_b32 s30, 2359296
    s_mov_b32 s34, 0x2000000
    s_mov_b32 s38, 0x2000000
    s_mov_b32 s42, 0x2000000
    s_mov_b32 s46, 0x2000000
    s_mov_b32 s50, 0x400000
    s_mov_b32 s54, 0x400000
    s_mov_b32 s58, 2048
    s_mov_b32 s62, 4096
    s_cmp_eq_u32 s67, 0
    s_waitcnt lgkmcnt(0)
    s_cselect_b32 s48, s10, s20
    s_cselect_b32 s49, s11, s21
    s_cselect_b32 s56, s4, s14
    s_cselect_b32 s57, s5, s15
    s_cselect_b32 s52, s12, s22
    s_cselect_b32 s53, s13, s23
    s_mov_b32 s28, s26
    s_and_b32 s29, s27, 0xffff
    s_and_b32 s49, s49, 0xffff
    buffer_load_dword v11, off, s[28:31], 0 offset:0 sc1
    s_mov_b32 s32, s6
    s_and_b32 s33, s7, 0xffff
    s_mov_b32 s40, s16
    s_and_b32 s41, s17, 0xffff
    buffer_load_dwordx4 v[24:27], v6, s[48:51], s72 offen nt
    s_add_u32 s72, s72, 8192
    buffer_load_dwordx4 v[28:31], v6, s[48:51], s72 offen nt
    s_add_u32 s72, s72, 8192
    buffer_load_dwordx4 v[32:35], v6, s[48:51], s72 offen nt
    s_add_u32 s72, s72, 8192
    buffer_load_dwordx4 v[36:39], v6, s[48:51], s72 offen nt
    s_add_u32 s72, s72, 8192
    buffer_load_dwordx4 v[40:43], v6, s[48:51], s72 offen nt
    s_add_u32 s72, s72, 8192
    buffer_load_dwordx4 v[44:47], v6, s[48:51], s72 offen nt
    s_add_u32 s72, s72, 8192
    buffer_load_dwordx4 v[48:51], v6, s[48:51], s72 offen nt
    s_add_u32 s72, s72, 8192
    buffer_load_dwordx4 v[52:55], v6, s[48:51], s72 offen nt
    s_and_b32 s57, s57, 0xffff
    buffer_load_dwordx4 v[120:123], v10, s[56:59], s76 offen
    s_mov_b32 s36, s8
    s_and_b32 s37, s9, 0xffff
    s_mov_b32 s44, s18
    s_and_b32 s45, s19, 0xffff
    s_mov_b32 s60, s24
    s_and_b32 s61, s25, 0xffff
    s_and_b32 s53, s53, 0xffff
    s_load_dword s14, s[6:7], s70
    s_load_dword s14, s[16:17], s3
    s_load_dword s14, s[8:9], s70
    s_load_dword s14, s[18:19], s3
    s_load_dword s14, s[24:25], 0
    s_load_dword s14, s[26:27], 0xFFFFC
    s_add_u32 s20, s26, 0x200000
    s_addc_u32 s21, s27, 0
    s_load_dword s14, s[20:21], 0
    s_add_u32 s4, s3, 0
    s_add_u32 s5, s3, 32768
    s_add_u32 s6, s3, 65536
    s_add_u32 s7, s3, 98304
    s_mov_b32 s80, 0x05040100
    s_mov_b32 s81, 0x07060302
    s_mov_b32 s82, 0x07060501
    s_mov_b32 s83, 0x07060502
    s_mov_b32 s84, 0x07060503
    s_mov_b32 s85, 0x04000c0c
    s_mov_b32 s86, 0x0706000c
    s_mov_b32 s87, 0x3e0293ee
    v_lshlrev_b32 v4, 4, v1
    v_add_u32 v5, 4096, v4
    v_lshrrev_b32 v7, 4, v1
    v_and_b32 v8, 15, v1
    v_lshlrev_b32 v12, 13, v7
    v_lshl_add_u32 v12, v8, 4, v12
    v_add_u32 v13, 4096, v12
    s_waitcnt vmcnt(9)
    v_readfirstlane_b32 s74, v11
    s_nop 0
    s_mul_i32 s69, s74, 0x9E3779B1
    s_add_u32 s69, s69, 0x85EBCA6B
    s_getreg_b32 s19, hwreg(HW_REG_XCC_ID)
    s_cmp_eq_u32 s64, 0
    s_cbranch_scc0 L_noxid
    s_lshl_b32 s74, s65, 8
    s_lshl_b32 s75, s66, 3
    s_add_u32 s74, s74, s75
    s_add_u32 s74, s74, 2048
    v_mov_b32 v106, s19
    v_mov_b32 v107, s69
    s_mov_b64 exec, 1
    buffer_store_dwordx2 v[106:107], off, s[28:31], s74 sc1
    s_mov_b64 exec, -1
L_noxid:
    s_lshl_b32 s74, s65, 4
    s_and_b32 s75, s66, 15
    s_add_u32 s74, s74, s75
    s_lshl_b32 s73, s74, 15
    s_lshl_b32 s75, s64, 8
    s_add_u32 s73, s73, s75
    s_load_dword s14, s[52:53], s73
    s_lshl_b32 s75, s74, 7
    s_lshl_b32 s76, s67, 19
    s_add_u32 s75, s75, s76
    s_lshl_b32 s76, s64, 16
    s_add_u32 s75, s75, s76
    s_add_u32 s98, s75, 1310720
    s_lshl_b32 s75, s67, 7
    s_add_u32 s74, s74, s75
    s_lshl_b32 s74, s74, 12
    s_add_u32 s97, s74, 262144
    s_lshl_b32 s74, s67, 3
    s_add_u32 s74, s74, s65
    s_lshl_b32 s74, s74, 1
    s_lshr_b32 s75, s64, 1
    s_add_u32 s74, s74, s75
    s_lshl_b32 s74, s74, 1
    s_and_b32 s75, s66, 1
    s_add_u32 s74, s74, s75
    s_lshl_b32 s74, s74, 11
    s_bfe_u32 s75, s66, 0x30001
    s_lshl_b32 s75, s75, 8
    s_add_u32 s74, s74, s75
    s_and_b32 s75, s64, 1
    s_lshl_b32 s75, s75, 7
    s_add_u32 s74, s74, s75
    s_add_u32 s89, s74, 8192
    s_lshr_b32 s74, s64, 1
    s_lshl_b32 s74, s74, 3
    s_add_u32 s74, s74, s79
    s_lshl_b32 s74, s74, 1
    s_add_u32 s74, s74, s78
    s_lshl_b32 s74, s74, 12
    s_and_b32 s75, s64, 1
    s_lshl_b32 s75, s75, 10
    s_add_u32 s74, s74, s75
    s_add_u32 s90, s74, 8192
    s_lshr_b32 s74, s71, 11
    s_add_u32 s93, s74, 139264
    s_add_u32 s94, s74, 155648
    s_lshl_b32 s74, s64, 8
    s_lshl_b32 s75, s68, 4
    s_add_u32 s74, s74, s75
    s_add_u32 s91, s93, s74
    s_add_u32 s92, s94, s74
    s_lshl_b32 s74, s79, 2
    s_add_u32 s74, s74, s64
    s_lshl_b32 s74, s74, 14
    s_lshl_b32 s75, s78, 4
    s_add_u32 s75, s75, s68
    s_lshl_b32 s75, s75, 7
    s_add_u32 s74, s74, s75
    s_add_u32 s95, s74, 262144
    s_add_u32 s96, s74, 786432
    s_lshl_b32 s76, s2, 14
    s_lshl_b32 s75, s64, 12
    s_add_u32 s76, s76, s75
    s_add_u32 s9, s76, 1310720
    s_add_u32 s10, s9, 1024
    s_add_u32 s11, s9, 2048
    s_add_u32 s12, s9, 3072
    s_bfe_u32 s76, s2, 0x10004
    s_lshl_b32 s76, s76, 11
    s_bfe_u32 s75, s2, 0x10005
    s_lshl_b32 s75, s75, 10
    s_add_u32 s76, s76, s75
    s_and_b32 s75, s2, 15
    s_lshl_b32 s75, s75, 6
    s_add_u32 s13, s76, s75
    v_lshrrev_b32 v7, 4, v1
    v_lshlrev_b32 v7, 8, v7
    v_and_b32 v8, 7, v1
    v_lshl_add_u32 v7, v8, 5, v7
    s_lshl_b32 s74, s64, 9
    v_add_u32 v7, s74, v7
    s_lshr_b32 s74, s64, 1
    s_lshl_b32 s74, s74, 8
    s_and_b32 s75, s64, 1
    s_lshl_b32 s75, s75, 7
    s_add_u32 s74, s74, s75
    v_lshlrev_b32 v9, 4, v8
    v_add_u32 v8, s74, v9
    s_waitcnt vmcnt(0)
    buffer_load_dwordx4 a[0:3], v2, s[32:35], s70 offen offset:0 nt
    buffer_load_dwordx4 a[4:7], v2, s[32:35], s70 offen offset:1024 nt
    buffer_load_dwordx4 a[8:11], v2, s[32:35], s70 offen offset:2048 nt
    buffer_load_dwordx4 a[12:15], v2, s[32:35], s70 offen offset:3072 nt
    buffer_load_dwordx4 a[16:19], v3, s[32:35], s70 offen offset:0 nt
    buffer_load_dwordx4 a[20:23], v3, s[32:35], s70 offen offset:1024 nt
    buffer_load_dwordx4 a[24:27], v3, s[32:35], s70 offen offset:2048 nt
    buffer_load_dwordx4 a[28:31], v3, s[32:35], s70 offen offset:3072 nt
    v_perm_b32 v104, v28, v24, s80
    v_perm_b32 v108, v28, v24, s81
    v_perm_b32 v105, v36, v32, s80
    v_perm_b32 v109, v36, v32, s81
    v_perm_b32 v106, v44, v40, s80
    v_perm_b32 v110, v44, v40, s81
    v_perm_b32 v107, v52, v48, s80
    v_perm_b32 v111, v52, v48, s81
    v_perm_b32 v112, v29, v25, s80
    v_perm_b32 v116, v29, v25, s81
    v_perm_b32 v113, v37, v33, s80
    v_perm_b32 v117, v37, v33, s81
    v_perm_b32 v114, v45, v41, s80
    v_perm_b32 v118, v45, v41, s81
    v_perm_b32 v115, v53, v49, s80
    v_perm_b32 v119, v53, v49, s81
    v_mfma_f32_16x16x32_bf16 v[72:75], v[120:123], v[104:107], 0
    v_mfma_f32_16x16x32_bf16 v[76:79], v[120:123], v[108:111], 0
    v_perm_b32 v104, v30, v26, s80
    v_perm_b32 v108, v30, v26, s81
    v_perm_b32 v105, v38, v34, s80
    v_perm_b32 v109, v38, v34, s81
    v_perm_b32 v106, v46, v42, s80
    v_perm_b32 v110, v46, v42, s81
    v_perm_b32 v107, v54, v50, s80
    v_perm_b32 v111, v54, v50, s81
    v_mfma_f32_16x16x32_bf16 v[80:83], v[120:123], v[112:115], 0
    v_mfma_f32_16x16x32_bf16 v[84:87], v[120:123], v[116:119], 0
    v_perm_b32 v112, v31, v27, s80
    v_perm_b32 v116, v31, v27, s81
    v_perm_b32 v113, v39, v35, s80
    v_perm_b32 v117, v39, v35, s81
    v_perm_b32 v114, v47, v43, s80
    v_perm_b32 v118, v47, v43, s81
    v_perm_b32 v115, v55, v51, s80
    v_perm_b32 v119, v55, v51, s81
    v_mfma_f32_16x16x32_bf16 v[88:91], v[120:123], v[104:107], 0
    v_mfma_f32_16x16x32_bf16 v[92:95], v[120:123], v[108:111], 0
    v_mfma_f32_16x16x32_bf16 v[96:99], v[120:123], v[112:115], 0
    v_mfma_f32_16x16x32_bf16 v[100:103], v[120:123], v[116:119], 0
    v_add_f32_dpp v104, v73, v72 row_ror:8 row_mask:0xf bank_mask:0xf
    v_add_f32_dpp v105, v77, v76 row_ror:8 row_mask:0xf bank_mask:0xf
    v_add_f32_dpp v106, v81, v80 row_ror:8 row_mask:0xf bank_mask:0xf
    v_add_f32_dpp v107, v85, v84 row_ror:8 row_mask:0xf bank_mask:0xf
    s_nop 0
    v_add_f32_dpp v108, v89, v88 row_ror:8 row_mask:0xf bank_mask:0xf
    v_add_f32_dpp v109, v93, v92 row_ror:8 row_mask:0xf bank_mask:0xf
    v_add_f32_dpp v110, v97, v96 row_ror:8 row_mask:0xf bank_mask:0xf
    v_add_f32_dpp v111, v101, v100 row_ror:8 row_mask:0xf bank_mask:0xf
    s_mov_b64 exec, 0x00ff00ff
    ds_write_b128 v7, v[104:107] offset:0
    ds_write_b128 v7, v[108:111] offset:16
    s_mov_b64 exec, -1
    s_waitcnt lgkmcnt(0)
    s_barrier
    ds_read_b128 v[72:75], v8 offset:0
    ds_read_b128 v[76:79], v8 offset:512
    ds_read_b128 v[80:83], v8 offset:1024
    ds_read_b128 v[84:87], v8 offset:1536
    s_waitcnt lgkmcnt(0)
    v_add_f32 v104, v72, v76
    v_add_f32 v105, v73, v77
    v_add_f32 v106, v74, v78
    v_add_f32 v107, v75, v79
    v_add_f32 v80, v80, v84
    v_add_f32 v81, v81, v85
    v_add_f32 v82, v82, v86
    v_add_f32 v83, v83, v87
    v_add_f32 v104, v104, v80
    v_add_f32 v105, v105, v81
    v_add_f32 v106, v106, v82
    v_add_f32 v107, v107, v83
    v_perm_b32 v108, v104, v105, s82
    v_perm_b32 v109, v106, v105, s83
    v_perm_b32 v110, v107, v105, s84
    v_mov_b32 v111, s69
    s_mov_b64 exec, 0xff
    buffer_store_dwordx4 v[108:111], v9, s[28:31], s89 offen sc1
    s_mov_b64 exec, -1
    s_barrier
    s_setprio 0
    buffer_load_dwordx4 a[32:35], v2, s[40:43], s3 offen offset:0 nt
    buffer_load_dwordx4 a[36:39], v2, s[40:43], s3 offen offset:1024 nt
    buffer_load_dwordx4 a[40:43], v2, s[40:43], s3 offen offset:2048 nt
    buffer_load_dwordx4 a[44:47], v2, s[40:43], s3 offen offset:3072 nt
    buffer_load_dwordx4 a[48:51], v3, s[40:43], s3 offen offset:0 nt
    buffer_load_dwordx4 a[52:55], v3, s[40:43], s3 offen offset:1024 nt
    buffer_load_dwordx4 a[56:59], v3, s[40:43], s3 offen offset:2048 nt
    buffer_load_dwordx4 a[60:63], v3, s[40:43], s3 offen offset:3072 nt
    buffer_load_dwordx4 a[64:67], v2, s[40:43], s5 offen offset:0 nt
    buffer_load_dwordx4 a[68:71], v2, s[40:43], s5 offen offset:1024 nt
    buffer_load_dwordx4 a[72:75], v2, s[40:43], s5 offen offset:2048 nt
    buffer_load_dwordx4 a[76:79], v2, s[40:43], s5 offen offset:3072 nt
    buffer_load_dwordx4 a[80:83], v3, s[40:43], s5 offen offset:0 nt
    buffer_load_dwordx4 a[84:87], v3, s[40:43], s5 offen offset:1024 nt
    buffer_load_dwordx4 a[88:91], v3, s[40:43], s5 offen offset:2048 nt
    buffer_load_dwordx4 a[92:95], v3, s[40:43], s5 offen offset:3072 nt
    v_and_b32 v7, 31, v1
    v_lshlrev_b32 v7, 3, v7
    s_lshl_b32 s74, s65, 8
    s_add_u32 s74, s74, 2048
    buffer_load_dwordx4 a[96:99], v2, s[40:43], s6 offen offset:0 nt
    buffer_load_dwordx4 a[100:103], v2, s[40:43], s6 offen offset:1024 nt
    buffer_load_dwordx4 a[104:107], v2, s[40:43], s6 offen offset:2048 nt
    buffer_load_dwordx4 a[108:111], v2, s[40:43], s6 offen offset:3072 nt
    buffer_load_dwordx4 a[112:115], v3, s[40:43], s6 offen offset:0 nt
    buffer_load_dwordx4 a[116:119], v3, s[40:43], s6 offen offset:1024 nt
    buffer_load_dwordx4 a[120:123], v3, s[40:43], s6 offen offset:2048 nt
    buffer_load_dwordx4 a[124:127], v3, s[40:43], s6 offen offset:3072 nt
    buffer_load_dwordx4 a[128:131], v2, s[40:43], s7 offen offset:0 nt
    buffer_load_dwordx4 a[132:135], v2, s[40:43], s7 offen offset:1024 nt
    buffer_load_dwordx4 a[136:139], v2, s[40:43], s7 offen offset:2048 nt
    buffer_load_dwordx4 a[140:143], v2, s[40:43], s7 offen offset:3072 nt
    buffer_load_dwordx2 v[124:125], v7, s[28:31], s74 offen sc1
    buffer_load_dwordx4 v[112:115], v4, s[28:31], s90 offen sc1
    buffer_load_dwordx4 v[116:119], v4, s[28:31], s90 offen offset:2048 sc1
    buffer_load_dwordx4 a[144:147], v3, s[40:43], s7 offen offset:0 nt
    buffer_load_dwordx4 a[148:151], v3, s[40:43], s7 offen offset:1024 nt
    buffer_load_dwordx4 a[152:155], v3, s[40:43], s7 offen offset:2048 nt
    buffer_load_dwordx4 a[156:159], v3, s[40:43], s7 offen offset:3072 nt
    s_barrier
    buffer_load_dwordx4 a[192:195], v4, s[36:39], s70 offen offset:0 nt
    buffer_load_dwordx4 a[196:199], v4, s[36:39], s70 offen offset:1024 nt
    buffer_load_dwordx4 a[200:203], v4, s[36:39], s70 offen offset:2048 nt
    buffer_load_dwordx4 a[204:207], v4, s[36:39], s70 offen offset:3072 nt
    buffer_load_dwordx4 a[208:211], v5, s[36:39], s70 offen offset:0 nt
    buffer_load_dwordx4 a[212:215], v5, s[36:39], s70 offen offset:1024 nt
    buffer_load_dwordx4 a[216:219], v5, s[36:39], s70 offen offset:2048 nt
    buffer_load_dwordx4 a[220:223], v5, s[36:39], s70 offen offset:3072 nt
    buffer_load_dwordx4 v[128:131], v4, s[44:47], s4 offen offset:0 nt
    buffer_load_dwordx4 v[132:135], v4, s[44:47], s4 offen offset:1024 nt
    s_waitcnt vmcnt(10)
    v_xor_b32 v10, s19, v124
    v_xor_b32 v15, s69, v125
    v_or_b32 v10, v10, v15
    v_cmp_ne_u32 vcc, 0, v10
    s_nop 0
    s_cmp_eq_u64 vcc, 0
    s_cselect_b32 s19, 1, 0
    s_mov_b32 s88, 0
L_q_retry:
    v_xor_b32 v15, s69, v115
    v_xor_b32 v10, s69, v119
    v_or_b32 v15, v15, v10
    v_cmp_ne_u32 vcc, 0, v15
    s_nop 0
    s_cmp_eq_u64 vcc, 0
    s_cbranch_scc1 L_q_ok
    s_add_u32 s88, s88, 1
    s_cmp_gt_u32 s88, 60000
    s_cbranch_scc1 L_q_ok
    s_sleep 2
    buffer_load_dwordx4 v[112:115], v4, s[28:31], s90 offen sc1
    buffer_load_dwordx4 v[116:119], v4, s[28:31], s90 offen offset:2048 sc1
    s_waitcnt vmcnt(0)
    s_branch L_q_retry
L_q_ok:
    v_perm_b32 v104, v114, v113, s85
    v_perm_b32 v104, v104, v112, s86
    v_perm_b32 v105, v118, v117, s85
    v_perm_b32 v105, v105, v116, s86
    v_add_f32 v106, v112, v116
    v_add_f32 v107, v104, v105
    v_add_f32 v108, v113, v117
    v_add_f32 v109, v114, v118
    v_cvt_pk_bf16_f32 v110, v106, v107
    v_cvt_pk_bf16_f32 v111, v108, v109
    s_lshl_b32 s74, s64, 9
    v_lshlrev_b32 v7, 3, v1
    v_add_u32 v7, s74, v7
    ds_write_b64 v7, v[110:111] offset:2048
    s_waitcnt lgkmcnt(0)
    s_barrier
    ds_read_b128 v[16:19], v2 offset:2048
    ds_read_b128 v[20:23], v2 offset:3072
    s_waitcnt lgkmcnt(0)
    v_mfma_f32_16x16x32_bf16 v[72:75], a[0:3], v[16:19], 0
    v_mfma_f32_16x16x32_bf16 v[76:79], a[4:7], v[16:19], 0
    v_mfma_f32_16x16x32_bf16 v[80:83], a[8:11], v[16:19], 0
    v_mfma_f32_16x16x32_bf16 v[84:87], a[12:15], v[16:19], 0
    v_mfma_f32_16x16x32_bf16 v[88:91], a[16:19], v[16:19], 0
    s_nop 3
    v_add_f32_dpp v24, v73, v72 quad_perm:[1,2,3,0] row_mask:0xf bank_mask:0xf
    v_add_f32_dpp v25, v77, v76 quad_perm:[1,2,3,0] row_mask:0xf bank_mask:0xf
    v_add_f32_dpp v26, v81, v80 quad_perm:[1,2,3,0] row_mask:0xf bank_mask:0xf
    v_mfma_f32_16x16x32_bf16 v[92:95], a[20:23], v[16:19], 0
    v_add_f32_dpp v27, v85, v84 quad_perm:[1,2,3,0] row_mask:0xf bank_mask:0xf
    v_add_f32_dpp v24, v74, v24 quad_perm:[2,3,0,1] row_mask:0xf bank_mask:0xf
    v_add_f32_dpp v25, v78, v25 quad_perm:[2,3,0,1] row_mask:0xf bank_mask:0xf
    v_mfma_f32_16x16x32_bf16 v[96:99], a[24:27], v[16:19], 0
    v_add_f32_dpp v26, v82, v26 quad_perm:[2,3,0,1] row_mask:0xf bank_mask:0xf
    v_add_f32_dpp v27, v86, v27 quad_perm:[2,3,0,1] row_mask:0xf bank_mask:0xf
    v_add_f32_dpp v24, v75, v24 quad_perm:[3,0,1,2] row_mask:0xf bank_mask:0xf
    v_mfma_f32_16x16x32_bf16 v[100:103], a[28:31], v[16:19], 0
    v_add_f32_dpp v25, v79, v25 quad_perm:[3,0,1,2] row_mask:0xf bank_mask:0xf
    v_add_f32_dpp v26, v83, v26 quad_perm:[3,0,1,2] row_mask:0xf bank_mask:0xf
    v_add_f32_dpp v27, v87, v27 quad_perm:[3,0,1,2] row_mask:0xf bank_mask:0xf
    v_mfma_f32_16x16x32_bf16 v[72:75], a[32:35], v[20:23], 0
    v_add_f32_dpp v28, v89, v88 quad_perm:[1,2,3,0] row_mask:0xf bank_mask:0xf
    v_add_f32_dpp v29, v93, v92 quad_perm:[1,2,3,0] row_mask:0xf bank_mask:0xf
    v_add_f32_dpp v30, v97, v96 quad_perm:[1,2,3,0] row_mask:0xf bank_mask:0xf
    v_mfma_f32_16x16x32_bf16 v[76:79], a[36:39], v[20:23], 0
    v_add_f32_dpp v31, v101, v100 quad_perm:[1,2,3,0] row_mask:0xf bank_mask:0xf
    v_add_f32_dpp v28, v90, v28 quad_perm:[2,3,0,1] row_mask:0xf bank_mask:0xf
    v_add_f32_dpp v29, v94, v29 quad_perm:[2,3,0,1] row_mask:0xf bank_mask:0xf
    v_mfma_f32_16x16x32_bf16 v[80:83], a[40:43], v[20:23], 0
    v_add_f32_dpp v30, v98, v30 quad_perm:[2,3,0,1] row_mask:0xf bank_mask:0xf
    v_add_f32_dpp v31, v102, v31 quad_perm:[2,3,0,1] row_mask:0xf bank_mask:0xf
    v_add_f32_dpp v28, v91, v28 quad_perm:[3,0,1,2] row_mask:0xf bank_mask:0xf
    v_mfma_f32_16x16x32_bf16 v[84:87], a[44:47], v[20:23], 0
    v_add_f32_dpp v29, v95, v29 quad_perm:[3,0,1,2] row_mask:0xf bank_mask:0xf
    v_add_f32_dpp v30, v99, v30 quad_perm:[3,0,1,2] row_mask:0xf bank_mask:0xf
    v_add_f32_dpp v31, v103, v31 quad_perm:[3,0,1,2] row_mask:0xf bank_mask:0xf
    v_mfma_f32_16x16x32_bf16 v[88:91], a[48:51], v[20:23], 0
    v_add_f32_dpp v32, v73, v72 quad_perm:[1,2,3,0] row_mask:0xf bank_mask:0xf
    v_add_f32_dpp v33, v77, v76 quad_perm:[1,2,3,0] row_mask:0xf bank_mask:0xf
    v_add_f32_dpp v34, v81, v80 quad_perm:[1,2,3,0] row_mask:0xf bank_mask:0xf
    v_mfma_f32_16x16x32_bf16 v[92:95], a[52:55], v[20:23], 0
    v_add_f32_dpp v35, v85, v84 quad_perm:[1,2,3,0] row_mask:0xf bank_mask:0xf
    v_add_f32_dpp v32, v74, v32 quad_perm:[2,3,0,1] row_mask:0xf bank_mask:0xf
    v_add_f32_dpp v33, v78, v33 quad_perm:[2,3,0,1] row_mask:0xf bank_mask:0xf
    v_mfma_f32_16x16x32_bf16 v[96:99], a[56:59], v[20:23], 0
    v_add_f32_dpp v34, v82, v34 quad_perm:[2,3,0,1] row_mask:0xf bank_mask:0xf
    v_add_f32_dpp v35, v86, v35 quad_perm:[2,3,0,1] row_mask:0xf bank_mask:0xf
    v_add_f32_dpp v32, v75, v32 quad_perm:[3,0,1,2] row_mask:0xf bank_mask:0xf
    v_mfma_f32_16x16x32_bf16 v[100:103], a[60:63], v[20:23], 0
    v_add_f32_dpp v33, v79, v33 quad_perm:[3,0,1,2] row_mask:0xf bank_mask:0xf
    v_add_f32_dpp v34, v83, v34 quad_perm:[3,0,1,2] row_mask:0xf bank_mask:0xf
    v_add_f32_dpp v35, v87, v35 quad_perm:[3,0,1,2] row_mask:0xf bank_mask:0xf
    v_mfma_f32_16x16x32_bf16 v[72:75], a[64:67], v[20:23], 0
    v_add_f32_dpp v36, v89, v88 quad_perm:[1,2,3,0] row_mask:0xf bank_mask:0xf
    v_add_f32_dpp v37, v93, v92 quad_perm:[1,2,3,0] row_mask:0xf bank_mask:0xf
    v_add_f32_dpp v38, v97, v96 quad_perm:[1,2,3,0] row_mask:0xf bank_mask:0xf
    v_mfma_f32_16x16x32_bf16 v[76:79], a[68:71], v[20:23], 0
    v_add_f32_dpp v39, v101, v100 quad_perm:[1,2,3,0] row_mask:0xf bank_mask:0xf
    v_add_f32_dpp v36, v90, v36 quad_perm:[2,3,0,1] row_mask:0xf bank_mask:0xf
    v_add_f32_dpp v37, v94, v37 quad_perm:[2,3,0,1] row_mask:0xf bank_mask:0xf
    v_mfma_f32_16x16x32_bf16 v[80:83], a[72:75], v[20:23], 0
    v_add_f32_dpp v38, v98, v38 quad_perm:[2,3,0,1] row_mask:0xf bank_mask:0xf
    v_add_f32_dpp v39, v102, v39 quad_perm:[2,3,0,1] row_mask:0xf bank_mask:0xf
    v_add_f32_dpp v36, v91, v36 quad_perm:[3,0,1,2] row_mask:0xf bank_mask:0xf
    v_mfma_f32_16x16x32_bf16 v[84:87], a[76:79], v[20:23], 0
    v_add_f32_dpp v37, v95, v37 quad_perm:[3,0,1,2] row_mask:0xf bank_mask:0xf
    v_add_f32_dpp v38, v99, v38 quad_perm:[3,0,1,2] row_mask:0xf bank_mask:0xf
    v_add_f32_dpp v39, v103, v39 quad_perm:[3,0,1,2] row_mask:0xf bank_mask:0xf
    v_mfma_f32_16x16x32_bf16 v[88:91], a[80:83], v[20:23], 0
    v_add_f32_dpp v40, v73, v72 quad_perm:[1,2,3,0] row_mask:0xf bank_mask:0xf
    v_add_f32_dpp v41, v77, v76 quad_perm:[1,2,3,0] row_mask:0xf bank_mask:0xf
    v_add_f32_dpp v42, v81, v80 quad_perm:[1,2,3,0] row_mask:0xf bank_mask:0xf
    v_mfma_f32_16x16x32_bf16 v[92:95], a[84:87], v[20:23], 0
    v_add_f32_dpp v43, v85, v84 quad_perm:[1,2,3,0] row_mask:0xf bank_mask:0xf
    v_add_f32_dpp v40, v74, v40 quad_perm:[2,3,0,1] row_mask:0xf bank_mask:0xf
    v_add_f32_dpp v41, v78, v41 quad_perm:[2,3,0,1] row_mask:0xf bank_mask:0xf
    v_mfma_f32_16x16x32_bf16 v[96:99], a[88:91], v[20:23], 0
    v_add_f32_dpp v42, v82, v42 quad_perm:[2,3,0,1] row_mask:0xf bank_mask:0xf
    v_add_f32_dpp v43, v86, v43 quad_perm:[2,3,0,1] row_mask:0xf bank_mask:0xf
    v_add_f32_dpp v40, v75, v40 quad_perm:[3,0,1,2] row_mask:0xf bank_mask:0xf
    v_mfma_f32_16x16x32_bf16 v[100:103], a[92:95], v[20:23], 0
    v_add_f32_dpp v41, v79, v41 quad_perm:[3,0,1,2] row_mask:0xf bank_mask:0xf
    v_add_f32_dpp v42, v83, v42 quad_perm:[3,0,1,2] row_mask:0xf bank_mask:0xf
    v_add_f32_dpp v43, v87, v43 quad_perm:[3,0,1,2] row_mask:0xf bank_mask:0xf
    v_mfma_f32_16x16x32_bf16 v[72:75], a[96:99], v[20:23], 0
    v_add_f32_dpp v44, v89, v88 quad_perm:[1,2,3,0] row_mask:0xf bank_mask:0xf
    v_add_f32_dpp v45, v93, v92 quad_perm:[1,2,3,0] row_mask:0xf bank_mask:0xf
    v_add_f32_dpp v46, v97, v96 quad_perm:[1,2,3,0] row_mask:0xf bank_mask:0xf
    v_mfma_f32_16x16x32_bf16 v[76:79], a[100:103], v[20:23], 0
    v_add_f32_dpp v47, v101, v100 quad_perm:[1,2,3,0] row_mask:0xf bank_mask:0xf
    v_add_f32_dpp v44, v90, v44 quad_perm:[2,3,0,1] row_mask:0xf bank_mask:0xf
    v_add_f32_dpp v45, v94, v45 quad_perm:[2,3,0,1] row_mask:0xf bank_mask:0xf
    v_mfma_f32_16x16x32_bf16 v[80:83], a[104:107], v[20:23], 0
    v_add_f32_dpp v46, v98, v46 quad_perm:[2,3,0,1] row_mask:0xf bank_mask:0xf
    v_add_f32_dpp v47, v102, v47 quad_perm:[2,3,0,1] row_mask:0xf bank_mask:0xf
    v_add_f32_dpp v44, v91, v44 quad_perm:[3,0,1,2] row_mask:0xf bank_mask:0xf
    v_mfma_f32_16x16x32_bf16 v[84:87], a[108:111], v[20:23], 0
    v_add_f32_dpp v45, v95, v45 quad_perm:[3,0,1,2] row_mask:0xf bank_mask:0xf
    v_add_f32_dpp v46, v99, v46 quad_perm:[3,0,1,2] row_mask:0xf bank_mask:0xf
    v_add_f32_dpp v47, v103, v47 quad_perm:[3,0,1,2] row_mask:0xf bank_mask:0xf
    v_mfma_f32_16x16x32_bf16 v[88:91], a[112:115], v[20:23], 0
    v_add_f32_dpp v48, v73, v72 quad_perm:[1,2,3,0] row_mask:0xf bank_mask:0xf
    v_add_f32_dpp v49, v77, v76 quad_perm:[1,2,3,0] row_mask:0xf bank_mask:0xf
    v_add_f32_dpp v50, v81, v80 quad_perm:[1,2,3,0] row_mask:0xf bank_mask:0xf
    v_mfma_f32_16x16x32_bf16 v[92:95], a[116:119], v[20:23], 0
    v_add_f32_dpp v51, v85, v84 quad_perm:[1,2,3,0] row_mask:0xf bank_mask:0xf
    v_add_f32_dpp v48, v74, v48 quad_perm:[2,3,0,1] row_mask:0xf bank_mask:0xf
    v_add_f32_dpp v49, v78, v49 quad_perm:[2,3,0,1] row_mask:0xf bank_mask:0xf
    v_mfma_f32_16x16x32_bf16 v[96:99], a[120:123], v[20:23], 0
    v_add_f32_dpp v50, v82, v50 quad_perm:[2,3,0,1] row_mask:0xf bank_mask:0xf
    v_add_f32_dpp v51, v86, v51 quad_perm:[2,3,0,1] row_mask:0xf bank_mask:0xf
    v_add_f32_dpp v48, v75, v48 quad_perm:[3,0,1,2] row_mask:0xf bank_mask:0xf
    v_mfma_f32_16x16x32_bf16 v[100:103], a[124:127], v[20:23], 0
    v_add_f32_dpp v49, v79, v49 quad_perm:[3,0,1,2] row_mask:0xf bank_mask:0xf
    v_add_f32_dpp v50, v83, v50 quad_perm:[3,0,1,2] row_mask:0xf bank_mask:0xf
    v_add_f32_dpp v51, v87, v51 quad_perm:[3,0,1,2] row_mask:0xf bank_mask:0xf
    v_mfma_f32_16x16x32_bf16 v[72:75], a[128:131], v[20:23], 0
    v_add_f32_dpp v52, v89, v88 quad_perm:[1,2,3,0] row_mask:0xf bank_mask:0xf
    v_add_f32_dpp v53, v93, v92 quad_perm:[1,2,3,0] row_mask:0xf bank_mask:0xf
    v_add_f32_dpp v54, v97, v96 quad_perm:[1,2,3,0] row_mask:0xf bank_mask:0xf
    v_mfma_f32_16x16x32_bf16 v[76:79], a[132:135], v[20:23], 0
    v_add_f32_dpp v55, v101, v100 quad_perm:[1,2,3,0] row_mask:0xf bank_mask:0xf
    v_add_f32_dpp v52, v90, v52 quad_perm:[2,3,0,1] row_mask:0xf bank_mask:0xf
    v_add_f32_dpp v53, v94, v53 quad_perm:[2,3,0,1] row_mask:0xf bank_mask:0xf
    v_mfma_f32_16x16x32_bf16 v[80:83], a[136:139], v[20:23], 0
    v_add_f32_dpp v54, v98, v54 quad_perm:[2,3,0,1] row_mask:0xf bank_mask:0xf
    v_add_f32_dpp v55, v102, v55 quad_perm:[2,3,0,1] row_mask:0xf bank_mask:0xf
    v_add_f32_dpp v52, v91, v52 quad_perm:[3,0,1,2] row_mask:0xf bank_mask:0xf
    v_mfma_f32_16x16x32_bf16 v[84:87], a[140:143], v[20:23], 0
    v_add_f32_dpp v53, v95, v53 quad_perm:[3,0,1,2] row_mask:0xf bank_mask:0xf
    v_add_f32_dpp v54, v99, v54 quad_perm:[3,0,1,2] row_mask:0xf bank_mask:0xf
    v_add_f32_dpp v55, v103, v55 quad_perm:[3,0,1,2] row_mask:0xf bank_mask:0xf
    v_mfma_f32_16x16x32_bf16 v[88:91], a[144:147], v[20:23], 0
    v_add_f32_dpp v56, v73, v72 quad_perm:[1,2,3,0] row_mask:0xf bank_mask:0xf
    v_add_f32_dpp v57, v77, v76 quad_perm:[1,2,3,0] row_mask:0xf bank_mask:0xf
    v_add_f32_dpp v58, v81, v80 quad_perm:[1,2,3,0] row_mask:0xf bank_mask:0xf
    v_mfma_f32_16x16x32_bf16 v[92:95], a[148:151], v[20:23], 0
    v_add_f32_dpp v59, v85, v84 quad_perm:[1,2,3,0] row_mask:0xf bank_mask:0xf
    v_add_f32_dpp v56, v74, v56 quad_perm:[2,3,0,1] row_mask:0xf bank_mask:0xf
    v_add_f32_dpp v57, v78, v57 quad_perm:[2,3,0,1] row_mask:0xf bank_mask:0xf
    v_mfma_f32_16x16x32_bf16 v[96:99], a[152:155], v[20:23], 0
    v_add_f32_dpp v58, v82, v58 quad_perm:[2,3,0,1] row_mask:0xf bank_mask:0xf
    v_add_f32_dpp v59, v86, v59 quad_perm:[2,3,0,1] row_mask:0xf bank_mask:0xf
    v_add_f32_dpp v56, v75, v56 quad_perm:[3,0,1,2] row_mask:0xf bank_mask:0xf
    v_mfma_f32_16x16x32_bf16 v[100:103], a[156:159], v[20:23], 0
    v_add_f32_dpp v57, v79, v57 quad_perm:[3,0,1,2] row_mask:0xf bank_mask:0xf
    v_add_f32_dpp v58, v83, v58 quad_perm:[3,0,1,2] row_mask:0xf bank_mask:0xf
    v_add_f32_dpp v59, v87, v59 quad_perm:[3,0,1,2] row_mask:0xf bank_mask:0xf
    v_add_f32_dpp v60, v89, v88 quad_perm:[1,2,3,0] row_mask:0xf bank_mask:0xf
    v_add_f32_dpp v61, v93, v92 quad_perm:[1,2,3,0] row_mask:0xf bank_mask:0xf
    v_add_f32_dpp v62, v97, v96 quad_perm:[1,2,3,0] row_mask:0xf bank_mask:0xf
    s_nop 1
    v_add_f32_dpp v63, v101, v100 quad_perm:[1,2,3,0] row_mask:0xf bank_mask:0xf
    v_add_f32_dpp v60, v90, v60 quad_perm:[2,3,0,1] row_mask:0xf bank_mask:0xf
    v_add_f32_dpp v61, v94, v61 quad_perm:[2,3,0,1] row_mask:0xf bank_mask:0xf
    v_add_f32_dpp v62, v98, v62 quad_perm:[2,3,0,1] row_mask:0xf bank_mask:0xf
    v_add_f32_dpp v63, v102, v63 quad_perm:[2,3,0,1] row_mask:0xf bank_mask:0xf
    v_add_f32_dpp v60, v91, v60 quad_perm:[3,0,1,2] row_mask:0xf bank_mask:0xf
    v_add_f32_dpp v61, v95, v61 quad_perm:[3,0,1,2] row_mask:0xf bank_mask:0xf
    v_add_f32_dpp v62, v99, v62 quad_perm:[3,0,1,2] row_mask:0xf bank_mask:0xf
    v_add_f32_dpp v63, v103, v63 quad_perm:[3,0,1,2] row_mask:0xf bank_mask:0xf
    v_max3_f32 v124, v24, v25, v26
    v_max3_f32 v126, v32, v33, v34
    v_max3_f32 v124, v124, v27, v28
    v_max3_f32 v124, v124, v29, v30
    v_max_f32 v124, v124, v31
    v_max3_f32 v126, v126, v35, v36
    v_max3_f32 v126, v126, v37, v38
    v_max3_f32 v126, v126, v39, v40
    v_max3_f32 v126, v126, v41, v42
    v_max3_f32 v126, v126, v43, v44
    v_max3_f32 v126, v126, v45, v46
    v_max3_f32 v126, v126, v47, v48
    v_max3_f32 v126, v126, v49, v50
    v_max3_f32 v126, v126, v51, v52
    v_max3_f32 v126, v126, v53, v54
    v_max3_f32 v126, v126, v55, v56
    v_max3_f32 v126, v126, v57, v58
    v_max3_f32 v126, v126, v59, v60
    v_max3_f32 v126, v126, v61, v62
    v_max_f32 v126, v126, v63
    v_mov_b32 v7, v124
    v_mov_b32 v8, v126
    s_nop 0
    v_permlane16_swap_b32 v124, v7
    v_permlane16_swap_b32 v126, v8
    v_max_f32 v124, v124, v7
    v_max_f32 v126, v126, v8
    v_mov_b32 v7, v124
    v_mov_b32 v8, v126
    s_nop 0
    v_permlane32_swap_b32 v124, v7
    v_permlane32_swap_b32 v126, v8
    v_max_f32 v124, v124, v7
    v_max_f32 v126, v126, v8
    v_mul_f32 v124, s87, v124
    v_mul_f32 v126, s87, v126
    v_fma_f32 v24, v24, s87, -v124
    v_fma_f32 v25, v25, s87, -v124
    v_fma_f32 v26, v26, s87, -v124
    v_fma_f32 v27, v27, s87, -v124
    v_fma_f32 v28, v28, s87, -v124
    v_fma_f32 v29, v29, s87, -v124
    v_fma_f32 v30, v30, s87, -v124
    v_fma_f32 v31, v31, s87, -v124
    v_fma_f32 v32, v32, s87, -v126
    v_fma_f32 v33, v33, s87, -v126
    v_fma_f32 v34, v34, s87, -v126
    v_fma_f32 v35, v35, s87, -v126
    v_fma_f32 v36, v36, s87, -v126
    v_fma_f32 v37, v37, s87, -v126
    v_fma_f32 v38, v38, s87, -v126
    v_fma_f32 v39, v39, s87, -v126
    v_fma_f32 v40, v40, s87, -v126
    v_fma_f32 v41, v41, s87, -v126
    v_fma_f32 v42, v42, s87, -v126
    v_fma_f32 v43, v43, s87, -v126
    v_fma_f32 v44, v44, s87, -v126
    v_fma_f32 v45, v45, s87, -v126
    v_fma_f32 v46, v46, s87, -v126
    v_fma_f32 v47, v47, s87, -v126
    v_fma_f32 v48, v48, s87, -v126
    v_fma_f32 v49, v49, s87, -v126
    v_fma_f32 v50, v50, s87, -v126
    v_fma_f32 v51, v51, s87, -v126
    v_fma_f32 v52, v52, s87, -v126
    v_fma_f32 v53, v53, s87, -v126
    v_fma_f32 v54, v54, s87, -v126
    v_fma_f32 v55, v55, s87, -v126
    v_fma_f32 v56, v56, s87, -v126
    v_fma_f32 v57, v57, s87, -v126
    v_fma_f32 v58, v58, s87, -v126
    v_fma_f32 v59, v59, s87, -v126
    v_fma_f32 v60, v60, s87, -v126
    v_fma_f32 v61, v61, s87, -v126
    v_fma_f32 v62, v62, s87, -v126
    v_fma_f32 v63, v63, s87, -v126
    v_exp_f32 v24, v24
    v_exp_f32 v25, v25
    v_exp_f32 v26, v26
    v_exp_f32 v27, v27
    v_exp_f32 v28, v28
    v_exp_f32 v29, v29
    v_exp_f32 v30, v30
    v_exp_f32 v31, v31
    v_exp_f32 v32, v32
    v_exp_f32 v33, v33
    v_exp_f32 v34, v34
    v_exp_f32 v35, v35
    v_exp_f32 v36, v36
    v_exp_f32 v37, v37
    v_exp_f32 v38, v38
    v_exp_f32 v39, v39
    v_exp_f32 v40, v40
    v_exp_f32 v41, v41
    v_exp_f32 v42, v42
    v_exp_f32 v43, v43
    v_exp_f32 v44, v44
    v_exp_f32 v45, v45
    v_exp_f32 v46, v46
    v_exp_f32 v47, v47
    v_exp_f32 v48, v48
    v_exp_f32 v49, v49
    v_exp_f32 v50, v50
    v_exp_f32 v51, v51
    v_exp_f32 v52, v52
    v_exp_f32 v53, v53
    v_exp_f32 v54, v54
    v_exp_f32 v55, v55
    v_exp_f32 v56, v56
    v_exp_f32 v57, v57
    v_exp_f32 v58, v58
    v_exp_f32 v59, v59
    v_exp_f32 v60, v60
    v_exp_f32 v61, v61
    v_exp_f32 v62, v62
    v_exp_f32 v63, v63
    v_add_f32 v125, v24, v25
    v_add_f32 v127, v32, v33
    v_add_f32 v125, v125, v26
    v_add_f32 v125, v125, v27
    v_add_f32 v125, v125, v28
    v_add_f32 v125, v125, v29
    v_add_f32 v125, v125, v30
    v_add_f32 v125, v125, v31
    v_add_f32 v127, v127, v34
    v_add_f32 v127, v127, v35
    v_add_f32 v127, v127, v36
    v_add_f32 v127, v127, v37
    v_add_f32 v127, v127, v38
    v_add_f32 v127, v127, v39
    v_add_f32 v127, v127, v40
    v_add_f32 v127, v127, v41
    v_add_f32 v127, v127, v42
    v_add_f32 v127, v127, v43
    v_add_f32 v127, v127, v44
    v_add_f32 v127, v127, v45
    v_add_f32 v127, v127, v46
    v_add_f32 v127, v127, v47
    v_add_f32 v127, v127, v48
    v_add_f32 v127, v127, v49
    v_add_f32 v127, v127, v50
    v_add_f32 v127, v127, v51
    v_add_f32 v127, v127, v52
    v_add_f32 v127, v127, v53
    v_add_f32 v127, v127, v54
    v_add_f32 v127, v127, v55
    v_add_f32 v127, v127, v56
    v_add_f32 v127, v127, v57
    v_add_f32 v127, v127, v58
    v_add_f32 v127, v127, v59
    v_add_f32 v127, v127, v60
    v_add_f32 v127, v127, v61
    v_add_f32 v127, v127, v62
    v_add_f32 v127, v127, v63
    v_cvt_pk_bf16_f32 v24, v24, v25
    v_cvt_pk_bf16_f32 v25, v26, v27
    v_cvt_pk_bf16_f32 v26, v28, v29
    v_cvt_pk_bf16_f32 v27, v30, v31
    v_cvt_pk_bf16_f32 v32, v32, v33
    v_cvt_pk_bf16_f32 v33, v34, v35
    v_cvt_pk_bf16_f32 v34, v36, v37
    v_cvt_pk_bf16_f32 v35, v38, v39
    v_cvt_pk_bf16_f32 v40, v40, v41
    v_cvt_pk_bf16_f32 v41, v42, v43
    v_cvt_pk_bf16_f32 v42, v44, v45
    v_cvt_pk_bf16_f32 v43, v46, v47
    v_cvt_pk_bf16_f32 v48, v48, v49
    v_cvt_pk_bf16_f32 v49, v50, v51
    v_cvt_pk_bf16_f32 v50, v52, v53
    v_cvt_pk_bf16_f32 v51, v54, v55
    v_cvt_pk_bf16_f32 v56, v56, v57
    v_cvt_pk_bf16_f32 v57, v58, v59
    v_cvt_pk_bf16_f32 v58, v60, v61
    v_cvt_pk_bf16_f32 v59, v62, v63
    v_mov_b32 v7, v125
    v_mov_b32 v8, v127
    s_nop 0
    v_permlane16_swap_b32 v125, v7
    v_permlane16_swap_b32 v127, v8
    v_add_f32 v125, v125, v7
    v_add_f32 v127, v127, v8
    v_mov_b32 v7, v125
    v_mov_b32 v8, v127
    s_nop 0
    v_permlane32_swap_b32 v125, v7
    v_permlane32_swap_b32 v127, v8
    v_add_f32 v125, v125, v7
    v_add_f32 v127, v127, v8
    v_lshlrev_b32 v7, 3, v1
    s_lshl_b32 s74, s64, 3
    v_add_u32 v7, s74, v7
    s_mov_b64 exec, 0x1111
    ds_write_b64 v7, v[124:125] offset:4096
    ds_write_b64 v7, v[126:127] offset:4224
    s_mov_b64 exec, -1
    s_waitcnt lgkmcnt(0)
    s_barrier
    v_lshrrev_b32 v7, 4, v1
    v_lshlrev_b32 v7, 5, v7
    v_add_u32 v8, s74, v7
    ds_read_b128 v[104:107], v7 offset:4096
    ds_read_b128 v[108:111], v7 offset:4112
    ds_read_b128 v[112:115], v7 offset:4224
    ds_read_b128 v[116:119], v7 offset:4240
    ds_read_b32 v124, v8 offset:4096
    ds_read_b32 v125, v8 offset:4224
    s_waitcnt lgkmcnt(0)
    v_max3_f32 v9, v104, v106, v108
    v_max3_f32 v7, v112, v114, v116
    v_max_f32 v9, v9, v110
    v_max_f32 v7, v7, v118
    v_sub_f32 v104, v104, v9
    v_sub_f32 v112, v112, v7
    v_sub_f32 v106, v106, v9
    v_sub_f32 v114, v114, v7
    v_sub_f32 v108, v108, v9
    v_sub_f32 v116, v116, v7
    v_sub_f32 v110, v110, v9
    v_sub_f32 v118, v118, v7
    v_exp_f32 v104, v104
    v_exp_f32 v112, v112
    v_exp_f32 v106, v106
    v_exp_f32 v114, v114
    v_exp_f32 v108, v108
    v_exp_f32 v116, v116
    v_exp_f32 v110, v110
    v_exp_f32 v118, v118
    v_mul_f32 v10, v104, v105
    v_mul_f32 v8, v112, v113
    v_fma_f32 v10, v106, v107, v10
    v_fma_f32 v8, v114, v115, v8
    v_fma_f32 v10, v108, v109, v10
    v_fma_f32 v8, v116, v117, v8
    v_fma_f32 v10, v110, v111, v10
    v_fma_f32 v8, v118, v119, v8
    v_log_f32 v10, v10
    v_log_f32 v8, v8
    v_mov_b32 v107, s69
    v_mov_b32 v115, s69
    v_add_f32 v104, v9, v10
    v_add_f32 v112, v7, v8
    s_setprio 3
    s_lshl_b32 s74, s64, 4
    s_lshl_b64 exec, 1, s74
    s_cmp_eq_u32 s19, 1
    s_cbranch_scc1 L_pl_l2
    buffer_store_dwordx4 v[104:107], off, s[28:31], s91 sc1
    buffer_store_dwordx4 v[112:115], off, s[28:31], s92 sc1
    s_branch L_pl_j
L_pl_l2:
    buffer_store_dwordx4 v[104:107], off, s[28:31], s91
    buffer_store_dwordx4 v[112:115], off, s[28:31], s92
L_pl_j:
    s_mov_b64 exec, -1
    s_setprio 0
    buffer_load_dwordx4 v[136:139], v4, s[44:47], s4 offen offset:2048 nt
    buffer_load_dwordx4 v[140:143], v4, s[44:47], s4 offen offset:3072 nt
    buffer_load_dwordx4 v[144:147], v5, s[44:47], s4 offen offset:0 nt
    buffer_load_dwordx4 v[148:151], v5, s[44:47], s4 offen offset:1024 nt
    buffer_load_dwordx4 v[152:155], v5, s[44:47], s4 offen offset:2048 nt
    buffer_load_dwordx4 v[156:159], v5, s[44:47], s4 offen offset:3072 nt
    s_waitcnt vmcnt(10)
    v_accvgpr_read_b32 v112, a192
    v_accvgpr_read_b32 v113, a196
    v_accvgpr_read_b32 v114, a200
    v_accvgpr_read_b32 v115, a204
    v_accvgpr_read_b32 v116, a208
    v_accvgpr_read_b32 v117, a212
    v_accvgpr_read_b32 v118, a216
    v_accvgpr_read_b32 v119, a220
    v_perm_b32 v104, v113, v112, s80
    v_perm_b32 v108, v113, v112, s81
    v_perm_b32 v105, v115, v114, s80
    v_perm_b32 v109, v115, v114, s81
    v_perm_b32 v106, v117, v116, s80
    v_perm_b32 v110, v117, v116, s81
    v_perm_b32 v107, v119, v118, s80
    v_perm_b32 v111, v119, v118, s81
    s_nop 0
    v_mfma_f32_16x16x32_bf16 v[72:75], v[24:27], v[104:107], 0
    v_mfma_f32_16x16x32_bf16 v[76:79], v[24:27], v[108:111], 0
    v_accvgpr_read_b32 v112, a193
    v_accvgpr_read_b32 v113, a197
    v_accvgpr_read_b32 v114, a201
    v_accvgpr_read_b32 v115, a205
    v_accvgpr_read_b32 v116, a209
    v_accvgpr_read_b32 v117, a213
    v_accvgpr_read_b32 v118, a217
    v_accvgpr_read_b32 v119, a221
    v_perm_b32 v104, v113, v112, s80
    v_perm_b32 v108, v113, v112, s81
    v_perm_b32 v105, v115, v114, s80
    v_perm_b32 v109, v115, v114, s81
    v_perm_b32 v106, v117, v116, s80
    v_perm_b32 v110, v117, v116, s81
    v_perm_b32 v107, v119, v118, s80
    v_perm_b32 v111, v119, v118, s81
    s_nop 0
    v_mfma_f32_16x16x32_bf16 v[80:83], v[24:27], v[104:107], 0
    v_mfma_f32_16x16x32_bf16 v[84:87], v[24:27], v[108:111], 0
    v_accvgpr_read_b32 v112, a194
    v_accvgpr_read_b32 v113, a198
    v_accvgpr_read_b32 v114, a202
    v_accvgpr_read_b32 v115, a206
    v_accvgpr_read_b32 v116, a210
    v_accvgpr_read_b32 v117, a214
    v_accvgpr_read_b32 v118, a218
    v_accvgpr_read_b32 v119, a222
    v_perm_b32 v104, v113, v112, s80
    v_perm_b32 v108, v113, v112, s81
    v_perm_b32 v105, v115, v114, s80
    v_perm_b32 v109, v115, v114, s81
    v_perm_b32 v106, v117, v116, s80
    v_perm_b32 v110, v117, v116, s81
    v_perm_b32 v107, v119, v118, s80
    v_perm_b32 v111, v119, v118, s81
    s_nop 0
    v_mfma_f32_16x16x32_bf16 v[88:91], v[24:27], v[104:107], 0
    v_mfma_f32_16x16x32_bf16 v[92:95], v[24:27], v[108:111], 0
    v_accvgpr_read_b32 v112, a195
    v_accvgpr_read_b32 v113, a199
    v_accvgpr_read_b32 v114, a203
    v_accvgpr_read_b32 v115, a207
    v_accvgpr_read_b32 v116, a211
    v_accvgpr_read_b32 v117, a215
    v_accvgpr_read_b32 v118, a219
    v_accvgpr_read_b32 v119, a223
    v_perm_b32 v104, v113, v112, s80
    v_perm_b32 v108, v113, v112, s81
    v_perm_b32 v105, v115, v114, s80
    v_perm_b32 v109, v115, v114, s81
    v_perm_b32 v106, v117, v116, s80
    v_perm_b32 v110, v117, v116, s81
    v_perm_b32 v107, v119, v118, s80
    v_perm_b32 v111, v119, v118, s81
    s_nop 0
    v_mfma_f32_16x16x32_bf16 v[96:99], v[24:27], v[104:107], 0
    v_mfma_f32_16x16x32_bf16 v[100:103], v[24:27], v[108:111], 0
    v_accvgpr_write_b32 a224, v72
    v_accvgpr_write_b32 a225, v76
    v_accvgpr_write_b32 a226, v80
    v_accvgpr_write_b32 a227, v84
    v_accvgpr_write_b32 a228, v88
    v_accvgpr_write_b32 a229, v92
    s_nop 0
    v_accvgpr_write_b32 a230, v96
    v_accvgpr_write_b32 a231, v100
    buffer_load_dwordx4 v[160:163], v4, s[44:47], s5 offen offset:0 nt
    buffer_load_dwordx4 v[164:167], v4, s[44:47], s5 offen offset:1024 nt
    buffer_load_dwordx4 v[168:171], v4, s[44:47], s5 offen offset:2048 nt
    buffer_load_dwordx4 v[172:175], v4, s[44:47], s5 offen offset:3072 nt
    buffer_load_dwordx4 v[176:179], v5, s[44:47], s5 offen offset:0 nt
    buffer_load_dwordx4 v[180:183], v5, s[44:47], s5 offen offset:1024 nt
    buffer_load_dwordx4 v[184:187], v5, s[44:47], s5 offen offset:2048 nt
    buffer_load_dwordx4 v[188:191], v5, s[44:47], s5 offen offset:3072 nt
    buffer_load_dwordx4 v[192:195], v4, s[44:47], s6 offen offset:0 nt
    buffer_load_dwordx4 v[196:199], v4, s[44:47], s6 offen offset:1024 nt
    s_waitcnt vmcnt(10)
    v_perm_b32 v104, v132, v128, s80
    v_perm_b32 v108, v132, v128, s81
    v_perm_b32 v105, v140, v136, s80
    v_perm_b32 v109, v140, v136, s81
    v_perm_b32 v106, v148, v144, s80
    v_perm_b32 v110, v148, v144, s81
    v_perm_b32 v107, v156, v152, s80
    v_perm_b32 v111, v156, v152, s81
    v_perm_b32 v112, v133, v129, s80
    v_perm_b32 v116, v133, v129, s81
    v_perm_b32 v113, v141, v137, s80
    v_perm_b32 v117, v141, v137, s81
    v_perm_b32 v114, v149, v145, s80
    v_perm_b32 v118, v149, v145, s81
    v_perm_b32 v115, v157, v153, s80
    v_perm_b32 v119, v157, v153, s81
    v_mfma_f32_16x16x32_bf16 v[72:75], v[32:35], v[104:107], 0
    v_mfma_f32_16x16x32_bf16 v[76:79], v[32:35], v[108:111], 0
    v_perm_b32 v104, v134, v130, s80
    v_perm_b32 v108, v134, v130, s81
    v_perm_b32 v105, v142, v138, s80
    v_perm_b32 v109, v142, v138, s81
    v_perm_b32 v106, v150, v146, s80
    v_perm_b32 v110, v150, v146, s81
    v_perm_b32 v107, v158, v154, s80
    v_perm_b32 v111, v158, v154, s81
    v_mfma_f32_16x16x32_bf16 v[80:83], v[32:35], v[112:115], 0
    v_mfma_f32_16x16x32_bf16 v[84:87], v[32:35], v[116:119], 0
    v_perm_b32 v112, v135, v131, s80
    v_perm_b32 v116, v135, v131, s81
    v_perm_b32 v113, v143, v139, s80
    v_perm_b32 v117, v143, v139, s81
    v_perm_b32 v114, v151, v147, s80
    v_perm_b32 v118, v151, v147, s81
    v_perm_b32 v115, v159, v155, s80
    v_perm_b32 v119, v159, v155, s81
    v_mfma_f32_16x16x32_bf16 v[88:91], v[32:35], v[104:107], 0
    v_mfma_f32_16x16x32_bf16 v[92:95], v[32:35], v[108:111], 0
    v_mfma_f32_16x16x32_bf16 v[96:99], v[32:35], v[112:115], 0
    v_mfma_f32_16x16x32_bf16 v[100:103], v[32:35], v[116:119], 0
    buffer_load_dwordx4 v[200:203], v4, s[44:47], s6 offen offset:2048 nt
    buffer_load_dwordx4 v[204:207], v4, s[44:47], s6 offen offset:3072 nt
    buffer_load_dwordx4 v[208:211], v5, s[44:47], s6 offen offset:0 nt
    buffer_load_dwordx4 v[212:215], v5, s[44:47], s6 offen offset:1024 nt
    buffer_load_dwordx4 v[216:219], v5, s[44:47], s6 offen offset:2048 nt
    buffer_load_dwordx4 v[220:223], v5, s[44:47], s6 offen offset:3072 nt
    buffer_load_dwordx4 v[120:123], v4, s[28:31], s93 offen sc1
    buffer_load_dwordx4 v[16:19], v4, s[28:31], s94 offen sc1
    s_waitcnt vmcnt(10)
    v_perm_b32 v104, v164, v160, s80
    v_perm_b32 v108, v164, v160, s81
    v_perm_b32 v105, v172, v168, s80
    v_perm_b32 v109, v172, v168, s81
    v_perm_b32 v106, v180, v176, s80
    v_perm_b32 v110, v180, v176, s81
    v_perm_b32 v107, v188, v184, s80
    v_perm_b32 v111, v188, v184, s81
    v_perm_b32 v112, v165, v161, s80
    v_perm_b32 v116, v165, v161, s81
    v_perm_b32 v113, v173, v169, s80
    v_perm_b32 v117, v173, v169, s81
    v_perm_b32 v114, v181, v177, s80
    v_perm_b32 v118, v181, v177, s81
    v_perm_b32 v115, v189, v185, s80
    v_perm_b32 v119, v189, v185, s81
    v_mfma_f32_16x16x32_bf16 v[72:75], v[40:43], v[104:107], v[72:75]
    v_mfma_f32_16x16x32_bf16 v[76:79], v[40:43], v[108:111], v[76:79]
    v_perm_b32 v104, v166, v162, s80
    v_perm_b32 v108, v166, v162, s81
    v_perm_b32 v105, v174, v170, s80
    v_perm_b32 v109, v174, v170, s81
    v_perm_b32 v106, v182, v178, s80
    v_perm_b32 v110, v182, v178, s81
    v_perm_b32 v107, v190, v186, s80
    v_perm_b32 v111, v190, v186, s81
    v_mfma_f32_16x16x32_bf16 v[80:83], v[40:43], v[112:115], v[80:83]
    v_mfma_f32_16x16x32_bf16 v[84:87], v[40:43], v[116:119], v[84:87]
    v_perm_b32 v112, v167, v163, s80
    v_perm_b32 v116, v167, v163, s81
    v_perm_b32 v113, v175, v171, s80
    v_perm_b32 v117, v175, v171, s81
    v_perm_b32 v114, v183, v179, s80
    v_perm_b32 v118, v183, v179, s81
    v_perm_b32 v115, v191, v187, s80
    v_perm_b32 v119, v191, v187, s81
    v_mfma_f32_16x16x32_bf16 v[88:91], v[40:43], v[104:107], v[88:91]
    v_mfma_f32_16x16x32_bf16 v[92:95], v[40:43], v[108:111], v[92:95]
    v_mfma_f32_16x16x32_bf16 v[96:99], v[40:43], v[112:115], v[96:99]
    v_mfma_f32_16x16x32_bf16 v[100:103], v[40:43], v[116:119], v[100:103]
    buffer_load_dwordx4 v[224:227], v4, s[44:47], s7 offen offset:0 nt
    buffer_load_dwordx4 v[228:231], v4, s[44:47], s7 offen offset:1024 nt
    buffer_load_dwordx4 v[232:235], v4, s[44:47], s7 offen offset:2048 nt
    buffer_load_dwordx4 v[236:239], v4, s[44:47], s7 offen offset:3072 nt
    buffer_load_dwordx4 v[240:243], v5, s[44:47], s7 offen offset:0 nt
    buffer_load_dwordx4 v[244:247], v5, s[44:47], s7 offen offset:1024 nt
    buffer_load_dwordx4 v[248:251], v5, s[44:47], s7 offen offset:2048 nt
    buffer_load_dwordx4 v[252:255], v5, s[44:47], s7 offen offset:3072 nt
    s_waitcnt vmcnt(10)
    v_perm_b32 v104, v196, v192, s80
    v_perm_b32 v108, v196, v192, s81
    v_perm_b32 v105, v204, v200, s80
    v_perm_b32 v109, v204, v200, s81
    v_perm_b32 v106, v212, v208, s80
    v_perm_b32 v110, v212, v208, s81
    v_perm_b32 v107, v220, v216, s80
    v_perm_b32 v111, v220, v216, s81
    v_perm_b32 v112, v197, v193, s80
    v_perm_b32 v116, v197, v193, s81
    v_perm_b32 v113, v205, v201, s80
    v_perm_b32 v117, v205, v201, s81
    v_perm_b32 v114, v213, v209, s80
    v_perm_b32 v118, v213, v209, s81
    v_perm_b32 v115, v221, v217, s80
    v_perm_b32 v119, v221, v217, s81
    v_mfma_f32_16x16x32_bf16 v[72:75], v[48:51], v[104:107], v[72:75]
    v_mfma_f32_16x16x32_bf16 v[76:79], v[48:51], v[108:111], v[76:79]
    v_perm_b32 v104, v198, v194, s80
    v_perm_b32 v108, v198, v194, s81
    v_perm_b32 v105, v206, v202, s80
    v_perm_b32 v109, v206, v202, s81
    v_perm_b32 v106, v214, v210, s80
    v_perm_b32 v110, v214, v210, s81
    v_perm_b32 v107, v222, v218, s80
    v_perm_b32 v111, v222, v218, s81
    v_mfma_f32_16x16x32_bf16 v[80:83], v[48:51], v[112:115], v[80:83]
    v_mfma_f32_16x16x32_bf16 v[84:87], v[48:51], v[116:119], v[84:87]
    v_perm_b32 v112, v199, v195, s80
    v_perm_b32 v116, v199, v195, s81
    v_perm_b32 v113, v207, v203, s80
    v_perm_b32 v117, v207, v203, s81
    v_perm_b32 v114, v215, v211, s80
    v_perm_b32 v118, v215, v211, s81
    v_perm_b32 v115, v223, v219, s80
    v_perm_b32 v119, v223, v219, s81
    v_mfma_f32_16x16x32_bf16 v[88:91], v[48:51], v[104:107], v[88:91]
    v_mfma_f32_16x16x32_bf16 v[92:95], v[48:51], v[108:111], v[92:95]
    v_mfma_f32_16x16x32_bf16 v[96:99], v[48:51], v[112:115], v[96:99]
    v_mfma_f32_16x16x32_bf16 v[100:103], v[48:51], v[116:119], v[100:103]
    buffer_load_dwordx4 v[160:163], v12, s[52:55], s73 offen offset:0 nt
    buffer_load_dwordx4 v[164:167], v12, s[52:55], s73 offen offset:1024 nt
    buffer_load_dwordx4 v[168:171], v12, s[52:55], s73 offen offset:2048 nt
    buffer_load_dwordx4 v[172:175], v12, s[52:55], s73 offen offset:3072 nt
    buffer_load_dwordx4 v[176:179], v13, s[52:55], s73 offen offset:0 nt
    buffer_load_dwordx4 v[180:183], v13, s[52:55], s73 offen offset:1024 nt
    buffer_load_dwordx4 v[184:187], v13, s[52:55], s73 offen offset:2048 nt
    buffer_load_dwordx4 v[188:191], v13, s[52:55], s73 offen offset:3072 nt
    v_lshlrev_b32 v14, 5, v1
    s_lshl_b32 s74, s64, 11
    v_add_u32 v14, s74, v14
    v_and_b32 v7, 31, v1
    v_lshlrev_b32 v8, 4, v7
    s_lshl_b32 s74, s64, 9
    v_add_u32 v2, s74, v8
    v_lshrrev_b32 v8, 3, v7
    v_lshlrev_b32 v3, 12, v8
    v_and_b32 v8, 7, v7
    v_lshl_add_u32 v3, v8, 4, v3
    v_lshrrev_b32 v7, 5, v1
    v_lshlrev_b32 v5, 11, v7
    v_and_b32 v8, 31, v1
    v_lshl_add_u32 v5, v8, 4, v5
    v_lshlrev_b32 v11, 6, v7
    v_and_b32 v8, 7, v1
    v_lshl_add_u32 v11, v8, 3, v11
    v_bfe_u32 v7, v1, 4, 1
    v_lshl_add_u32 v11, v7, 2, v11
    v_and_b32 v8, 3, v1
    v_bfe_u32 v9, v1, 2, 1
    v_lshrrev_b32 v7, 4, v1
    v_lshlrev_b32 v6, 4, v8
    v_lshl_add_u32 v6, v9, 3, v6
    v_lshl_add_u32 v6, v7, 1, v6
    v_lshlrev_b32 v13, 6, v9
    v_lshl_add_u32 v13, v7, 4, v13
    v_lshlrev_b32 v12, 18, v7
    v_bfe_u32 v9, v1, 2, 2
    v_lshl_add_u32 v12, v9, 14, v12
    v_lshl_add_u32 v12, v8, 4, v12
    s_waitcnt vmcnt(16)
    s_mov_b32 s88, 0
L_l_retry:
    v_xor_b32 v15, s69, v123
    v_xor_b32 v10, s69, v19
    v_or_b32 v15, v15, v10
    v_cmp_ne_u32 vcc, 0, v15
    s_nop 0
    s_cmp_eq_u64 vcc, 0
    s_cbranch_scc1 L_l_ok
    s_add_u32 s88, s88, 1
    s_cmp_gt_u32 s88, 60000
    s_cbranch_scc1 L_l_ok
    s_sleep 2
    buffer_load_dwordx4 v[120:123], v4, s[28:31], s93 offen sc1
    buffer_load_dwordx4 v[16:19], v4, s[28:31], s94 offen sc1
    s_waitcnt vmcnt(0)
    s_branch L_l_retry
L_l_ok:
    v_max_f32_dpp v121, v120, v120 row_ror:8 row_mask:0xf bank_mask:0xf
    v_max_f32_dpp v17, v16, v16 row_ror:8 row_mask:0xf bank_mask:0xf
    s_nop 0
    v_max_f32_dpp v122, v121, v121 row_ror:4 row_mask:0xf bank_mask:0xf
    v_max_f32_dpp v18, v17, v17 row_ror:4 row_mask:0xf bank_mask:0xf
    s_nop 0
    v_max_f32_dpp v121, v122, v122 row_ror:2 row_mask:0xf bank_mask:0xf
    v_max_f32_dpp v17, v18, v18 row_ror:2 row_mask:0xf bank_mask:0xf
    s_nop 0
    v_max_f32_dpp v122, v121, v121 row_ror:1 row_mask:0xf bank_mask:0xf
    v_max_f32_dpp v18, v17, v17 row_ror:1 row_mask:0xf bank_mask:0xf
    v_sub_f32 v120, v120, v122
    v_sub_f32 v16, v16, v18
    v_exp_f32 v120, v120
    v_exp_f32 v16, v16
    s_nop 0
    v_add_f32_dpp v121, v120, v120 row_ror:8 row_mask:0xf bank_mask:0xf
    v_add_f32_dpp v17, v16, v16 row_ror:8 row_mask:0xf bank_mask:0xf
    s_nop 0
    v_add_f32_dpp v120, v121, v121 row_ror:4 row_mask:0xf bank_mask:0xf
    v_add_f32_dpp v16, v17, v17 row_ror:4 row_mask:0xf bank_mask:0xf
    s_nop 0
    v_add_f32_dpp v121, v120, v120 row_ror:2 row_mask:0xf bank_mask:0xf
    v_add_f32_dpp v17, v16, v16 row_ror:2 row_mask:0xf bank_mask:0xf
    s_nop 0
    v_add_f32_dpp v120, v121, v121 row_ror:1 row_mask:0xf bank_mask:0xf
    v_add_f32_dpp v16, v17, v17 row_ror:1 row_mask:0xf bank_mask:0xf
    v_log_f32 v120, v120
    v_log_f32 v16, v16
    v_add_f32 v120, v120, v122
    v_add_f32 v16, v16, v18
    v_sub_f32 v124, v124, v120
    v_sub_f32 v125, v125, v16
    v_exp_f32 v124, v124
    v_exp_f32 v125, v125
    v_accvgpr_read_b32 v112, a224
    v_accvgpr_read_b32 v113, a225
    v_accvgpr_read_b32 v114, a226
    v_accvgpr_read_b32 v115, a227
    v_accvgpr_read_b32 v116, a228
    v_accvgpr_read_b32 v117, a229
    v_accvgpr_read_b32 v118, a230
    v_accvgpr_read_b32 v119, a231
    v_mul_f32 v112, v112, v124
    v_mul_f32 v113, v113, v124
    v_mul_f32 v114, v114, v124
    v_mul_f32 v115, v115, v124
    v_mul_f32 v116, v116, v124
    v_mul_f32 v117, v117, v124
    v_mul_f32 v118, v118, v124
    v_mul_f32 v119, v119, v124
    ds_write_b128 v14, v[112:115] offset:8192
    ds_write_b128 v14, v[116:119] offset:8208
    s_waitcnt vmcnt(8)
    v_perm_b32 v104, v228, v224, s80
    v_perm_b32 v108, v228, v224, s81
    v_perm_b32 v105, v236, v232, s80
    v_perm_b32 v109, v236, v232, s81
    v_perm_b32 v106, v244, v240, s80
    v_perm_b32 v110, v244, v240, s81
    v_perm_b32 v107, v252, v248, s80
    v_perm_b32 v111, v252, v248, s81
    v_perm_b32 v112, v229, v225, s80
    v_perm_b32 v116, v229, v225, s81
    v_perm_b32 v113, v237, v233, s80
    v_perm_b32 v117, v237, v233, s81
    v_perm_b32 v114, v245, v241, s80
    v_perm_b32 v118, v245, v241, s81
    v_perm_b32 v115, v253, v249, s80
    v_perm_b32 v119, v253, v249, s81
    v_mfma_f32_16x16x32_bf16 v[72:75], v[56:59], v[104:107], v[72:75]
    v_mfma_f32_16x16x32_bf16 v[76:79], v[56:59], v[108:111], v[76:79]
    v_perm_b32 v104, v230, v226, s80
    v_perm_b32 v108, v230, v226, s81
    v_perm_b32 v105, v238, v234, s80
    v_perm_b32 v109, v238, v234, s81
    v_perm_b32 v106, v246, v242, s80
    v_perm_b32 v110, v246, v242, s81
    v_perm_b32 v107, v254, v250, s80
    v_perm_b32 v111, v254, v250, s81
    v_mfma_f32_16x16x32_bf16 v[80:83], v[56:59], v[112:115], v[80:83]
    v_mfma_f32_16x16x32_bf16 v[84:87], v[56:59], v[116:119], v[84:87]
    v_perm_b32 v112, v231, v227, s80
    v_perm_b32 v116, v231, v227, s81
    v_perm_b32 v113, v239, v235, s80
    v_perm_b32 v117, v239, v235, s81
    v_perm_b32 v114, v247, v243, s80
    v_perm_b32 v118, v247, v243, s81
    v_perm_b32 v115, v255, v251, s80
    v_perm_b32 v119, v255, v251, s81
    v_mfma_f32_16x16x32_bf16 v[88:91], v[56:59], v[104:107], v[88:91]
    v_mfma_f32_16x16x32_bf16 v[92:95], v[56:59], v[108:111], v[92:95]
    v_mfma_f32_16x16x32_bf16 v[96:99], v[56:59], v[112:115], v[96:99]
    v_mfma_f32_16x16x32_bf16 v[100:103], v[56:59], v[116:119], v[100:103]
    v_mul_f32 v104, v72, v125
    v_mul_f32 v105, v76, v125
    v_mul_f32 v106, v80, v125
    v_mul_f32 v107, v84, v125
    s_nop 0
    v_mul_f32 v108, v88, v125
    v_mul_f32 v109, v92, v125
    v_mul_f32 v110, v96, v125
    v_mul_f32 v111, v100, v125
    ds_write_b128 v14, v[104:107] offset:16384
    ds_write_b128 v14, v[108:111] offset:16400
    v_lshlrev_b32 v17, 2, v1
    s_lshl_b32 s74, s64, 8
    v_add_u32 v16, s74, v17
    v_lshlrev_b32 v4, 4, v1
    s_waitcnt lgkmcnt(0)
    s_barrier
    ds_read_b128 v[104:107], v2 offset:16384
    ds_read_b128 v[108:111], v2 offset:18432
    ds_read_b128 v[112:115], v2 offset:20480
    ds_read_b128 v[116:119], v2 offset:22528
    ds_read_b128 v[72:75], v2 offset:8192
    ds_read_b128 v[76:79], v2 offset:10240
    ds_read_b128 v[80:83], v2 offset:12288
    ds_read_b128 v[84:87], v2 offset:14336
    s_waitcnt lgkmcnt(4)
    v_add_f32 v104, v104, v108
    v_add_f32 v105, v105, v109
    v_add_f32 v106, v106, v110
    v_add_f32 v107, v107, v111
    v_add_f32 v112, v112, v116
    v_add_f32 v113, v113, v117
    v_add_f32 v114, v114, v118
    v_add_f32 v115, v115, v119
    v_add_f32 v104, v104, v112
    v_add_f32 v105, v105, v113
    v_add_f32 v106, v106, v114
    v_add_f32 v107, v107, v115
    v_perm_b32 v108, v104, v105, s82
    v_perm_b32 v109, v106, v105, s83
    v_perm_b32 v110, v107, v105, s84
    v_mov_b32 v111, s69
    s_mov_b32 exec_hi, 0
    s_cmp_eq_u32 s19, 1
    s_cbranch_scc1 L_sb_l2
    buffer_store_dwordx4 v[108:111], v3, s[28:31], s96 offen sc1
    s_branch L_sb_j
L_sb_l2:
    buffer_store_dwordx4 v[108:111], v3, s[28:31], s96 offen
L_sb_j:
    s_mov_b64 exec, -1
    s_waitcnt lgkmcnt(0)
    v_add_f32 v72, v72, v76
    v_add_f32 v73, v73, v77
    v_add_f32 v74, v74, v78
    v_add_f32 v75, v75, v79
    v_add_f32 v80, v80, v84
    v_add_f32 v81, v81, v85
    v_add_f32 v82, v82, v86
    v_add_f32 v83, v83, v87
    v_add_f32 v72, v72, v80
    v_add_f32 v73, v73, v81
    v_add_f32 v74, v74, v82
    v_add_f32 v75, v75, v83
    v_perm_b32 v76, v72, v73, s82
    v_perm_b32 v77, v74, v73, s83
    v_perm_b32 v78, v75, v73, s84
    v_mov_b32 v79, s69
    s_mov_b32 exec_hi, 0
    s_cmp_eq_u32 s19, 1
    s_cbranch_scc1 L_sa_l2
    buffer_store_dwordx4 v[76:79], v3, s[28:31], s95 offen sc1
    s_branch L_sa_j
L_sa_l2:
    buffer_store_dwordx4 v[76:79], v3, s[28:31], s95 offen
L_sa_j:
    s_mov_b64 exec, -1
    s_cmp_eq_u32 s64, 0
    s_cbranch_scc0 L_s2_w123
    buffer_load_dwordx4 v[24:27], v5, s[28:31], s97 offen offset:0 sc1
    buffer_load_dwordx4 v[28:31], v5, s[28:31], s97 offen offset:512 sc1
    buffer_load_dwordx4 v[32:35], v5, s[28:31], s97 offen offset:1024 sc1
    buffer_load_dwordx4 v[36:39], v5, s[28:31], s97 offen offset:1536 sc1
    s_waitcnt vmcnt(12)
    v_perm_b32 v192, v164, v160, s80
    v_perm_b32 v196, v164, v160, s81
    v_perm_b32 v200, v165, v161, s80
    v_perm_b32 v204, v165, v161, s81
    v_perm_b32 v208, v166, v162, s80
    v_perm_b32 v212, v166, v162, s81
    v_perm_b32 v216, v167, v163, s80
    v_perm_b32 v220, v167, v163, s81
    s_waitcnt vmcnt(10)
    v_perm_b32 v193, v172, v168, s80
    v_perm_b32 v197, v172, v168, s81
    v_perm_b32 v201, v173, v169, s80
    v_perm_b32 v205, v173, v169, s81
    v_perm_b32 v209, v174, v170, s80
    v_perm_b32 v213, v174, v170, s81
    v_perm_b32 v217, v175, v171, s80
    v_perm_b32 v221, v175, v171, s81
    s_waitcnt vmcnt(8)
    v_perm_b32 v194, v180, v176, s80
    v_perm_b32 v198, v180, v176, s81
    v_perm_b32 v202, v181, v177, s80
    v_perm_b32 v206, v181, v177, s81
    v_perm_b32 v210, v182, v178, s80
    v_perm_b32 v214, v182, v178, s81
    v_perm_b32 v218, v183, v179, s80
    v_perm_b32 v222, v183, v179, s81
    s_waitcnt vmcnt(6)
    v_perm_b32 v195, v188, v184, s80
    v_perm_b32 v199, v188, v184, s81
    v_perm_b32 v203, v189, v185, s80
    v_perm_b32 v207, v189, v185, s81
    v_perm_b32 v211, v190, v186, s80
    v_perm_b32 v215, v190, v186, s81
    v_perm_b32 v219, v191, v187, s80
    v_perm_b32 v223, v191, v187, s81
    s_branch L_s2_wj
L_s2_w123:
    s_waitcnt vmcnt(8)
    v_perm_b32 v192, v164, v160, s80
    v_perm_b32 v196, v164, v160, s81
    v_perm_b32 v200, v165, v161, s80
    v_perm_b32 v204, v165, v161, s81
    v_perm_b32 v208, v166, v162, s80
    v_perm_b32 v212, v166, v162, s81
    v_perm_b32 v216, v167, v163, s80
    v_perm_b32 v220, v167, v163, s81
    s_waitcnt vmcnt(6)
    v_perm_b32 v193, v172, v168, s80
    v_perm_b32 v197, v172, v168, s81
    v_perm_b32 v201, v173, v169, s80
    v_perm_b32 v205, v173, v169, s81
    v_perm_b32 v209, v174, v170, s80
    v_perm_b32 v213, v174, v170, s81
    v_perm_b32 v217, v175, v171, s80
    v_perm_b32 v221, v175, v171, s81
    s_waitcnt vmcnt(4)
    v_perm_b32 v194, v180, v176, s80
    v_perm_b32 v198, v180, v176, s81
    v_perm_b32 v202, v181, v177, s80
    v_perm_b32 v206, v181, v177, s81
    v_perm_b32 v210, v182, v178, s80
    v_perm_b32 v214, v182, v178, s81
    v_perm_b32 v218, v183, v179, s80
    v_perm_b32 v222, v183, v179, s81
    s_waitcnt vmcnt(2)
    v_perm_b32 v195, v188, v184, s80
    v_perm_b32 v199, v188, v184, s81
    v_perm_b32 v203, v189, v185, s80
    v_perm_b32 v207, v189, v185, s81
    v_perm_b32 v211, v190, v186, s80
    v_perm_b32 v215, v190, v186, s81
    v_perm_b32 v219, v191, v187, s80
    v_perm_b32 v223, v191, v187, s81
L_s2_wj:
    s_cmp_eq_u32 s64, 0
    s_cbranch_scc0 L_s2_join
    s_waitcnt vmcnt(0)
    s_mov_b32 s88, 0
L_h2_retry:
    v_xor_b32 v15, s69, v27
    v_xor_b32 v10, s69, v31
    v_xor_b32 v9, s69, v35
    v_or3_b32 v15, v15, v10, v9
    v_xor_b32 v10, s69, v39
    v_or_b32 v15, v15, v10
    v_cmp_ne_u32 vcc, 0, v15
    s_nop 0
    s_cmp_eq_u64 vcc, 0
    s_cbranch_scc1 L_h2_ok
    s_add_u32 s88, s88, 1
    s_cmp_gt_u32 s88, 60000
    s_cbranch_scc1 L_h2_ok
    s_sleep 2
    buffer_load_dwordx4 v[24:27], v5, s[28:31], s97 offen offset:0 sc1
    buffer_load_dwordx4 v[28:31], v5, s[28:31], s97 offen offset:512 sc1
    buffer_load_dwordx4 v[32:35], v5, s[28:31], s97 offen offset:1024 sc1
    buffer_load_dwordx4 v[36:39], v5, s[28:31], s97 offen offset:1536 sc1
    s_waitcnt vmcnt(0)
    s_branch L_h2_retry
L_h2_ok:
    v_perm_b32 v27, v26, v25, s85
    v_perm_b32 v27, v27, v24, s86
    v_perm_b32 v31, v30, v29, s85
    v_perm_b32 v31, v31, v28, s86
    v_perm_b32 v35, v34, v33, s85
    v_perm_b32 v35, v35, v32, s86
    v_perm_b32 v39, v38, v37, s85
    v_perm_b32 v39, v39, v36, s86
    v_add_f32 v24, v24, v28
    v_add_f32 v25, v25, v29
    v_add_f32 v26, v26, v30
    v_add_f32 v27, v27, v31
    v_add_f32 v32, v32, v36
    v_add_f32 v33, v33, v37
    v_add_f32 v34, v34, v38
    v_add_f32 v35, v35, v39
    v_add_f32 v24, v24, v32
    v_add_f32 v25, v25, v33
    v_add_f32 v26, v26, v34
    v_add_f32 v27, v27, v35
    v_add_f32_dpp v28, v24, v24 row_ror:8 row_mask:0xf bank_mask:0xf
    v_add_f32_dpp v29, v25, v25 row_ror:8 row_mask:0xf bank_mask:0xf
    v_add_f32_dpp v30, v26, v26 row_ror:8 row_mask:0xf bank_mask:0xf
    v_add_f32_dpp v31, v27, v27 row_ror:8 row_mask:0xf bank_mask:0xf
    v_permlane16_swap_b32 v28, v29
    s_nop 0
    v_permlane16_swap_b32 v31, v30
    v_add_f32 v28, v28, v29
    v_add_f32 v31, v31, v30
    v_cvt_pk_bf16_f32 v24, v28, v31
    ds_write_b32 v11, v24 offset:4352
    s_waitcnt lgkmcnt(0)
L_s2_join:
    s_barrier
    ds_read_b128 v[120:123], v13 offset:4352
    s_waitcnt lgkmcnt(0)
    v_mfma_f32_16x16x32_bf16 v[72:75], v[120:123], v[192:195], 0
    v_mfma_f32_16x16x32_bf16 v[76:79], v[120:123], v[196:199], 0
    v_mfma_f32_16x16x32_bf16 v[80:83], v[120:123], v[200:203], 0
    v_mfma_f32_16x16x32_bf16 v[84:87], v[120:123], v[204:207], 0
    v_mfma_f32_16x16x32_bf16 v[88:91], v[120:123], v[208:211], 0
    v_mfma_f32_16x16x32_bf16 v[92:95], v[120:123], v[212:215], 0
    v_mfma_f32_16x16x32_bf16 v[96:99], v[120:123], v[216:219], 0
    v_mfma_f32_16x16x32_bf16 v[100:103], v[120:123], v[220:223], 0
    s_nop 1
    v_perm_b32 v104, v72, v76, s82
    v_perm_b32 v105, v80, v76, s83
    v_perm_b32 v106, v84, v76, s84
    v_mov_b32 v107, s69
    v_perm_b32 v108, v88, v92, s82
    v_perm_b32 v109, v96, v92, s83
    v_perm_b32 v110, v100, v92, s84
    v_mov_b32 v111, s69
    s_mov_b32 exec_hi, 0
    buffer_store_dwordx4 v[104:107], v12, s[28:31], s98 offen sc1
    buffer_store_dwordx4 v[108:111], v12, s[28:31], s98 offen offset:64 sc1
    s_mov_b64 exec, -1
    s_cmp_lt_u32 s2, 64
    s_cbranch_scc0 L_fin
    buffer_load_dwordx4 v[24:27], v4, s[28:31], s9 offen sc1
    buffer_load_dwordx4 v[28:31], v4, s[28:31], s10 offen sc1
    buffer_load_dwordx4 v[32:35], v4, s[28:31], s11 offen sc1
    buffer_load_dwordx4 v[36:39], v4, s[28:31], s12 offen sc1
    s_waitcnt vmcnt(0)
    s_mov_b32 s88, 0
L_h3_retry:
    v_xor_b32 v15, s69, v27
    v_xor_b32 v10, s69, v31
    v_xor_b32 v9, s69, v35
    v_or3_b32 v15, v15, v10, v9
    v_xor_b32 v10, s69, v39
    v_or_b32 v15, v15, v10
    v_cmp_ne_u32 vcc, 0, v15
    s_nop 0
    s_cmp_eq_u64 vcc, 0
    s_cbranch_scc1 L_h3_ok
    s_add_u32 s88, s88, 1
    s_cmp_gt_u32 s88, 60000
    s_cbranch_scc1 L_h3_ok
    s_sleep 2
    buffer_load_dwordx4 v[24:27], v4, s[28:31], s9 offen sc1
    buffer_load_dwordx4 v[28:31], v4, s[28:31], s10 offen sc1
    buffer_load_dwordx4 v[32:35], v4, s[28:31], s11 offen sc1
    buffer_load_dwordx4 v[36:39], v4, s[28:31], s12 offen sc1
    s_waitcnt vmcnt(0)
    s_branch L_h3_retry
L_h3_ok:
    v_perm_b32 v27, v26, v25, s85
    v_perm_b32 v27, v27, v24, s86
    v_perm_b32 v31, v30, v29, s85
    v_perm_b32 v31, v31, v28, s86
    v_perm_b32 v35, v34, v33, s85
    v_perm_b32 v35, v35, v32, s86
    v_perm_b32 v39, v38, v37, s85
    v_perm_b32 v39, v39, v36, s86
    v_add_f32 v24, v24, v28
    v_add_f32 v25, v25, v29
    v_add_f32 v26, v26, v30
    v_add_f32 v27, v27, v31
    v_add_f32 v32, v32, v36
    v_add_f32 v33, v33, v37
    v_add_f32 v34, v34, v38
    v_add_f32 v35, v35, v39
    v_add_f32 v24, v24, v32
    v_add_f32 v25, v25, v33
    v_add_f32 v26, v26, v34
    v_add_f32 v27, v27, v35
    s_nop 1
    v_permlane16_swap_b32 v24, v27
    v_permlane16_swap_b32 v25, v26
    v_add_f32 v24, v24, v27
    v_add_f32 v25, v25, v26
    s_nop 1
    v_permlane32_swap_b32 v24, v25
    v_add_f32 v24, v24, v25
    s_nop 1
    v_add_f32_dpp v25, v24, v24 row_ror:8 row_mask:0xf bank_mask:0xf
    ds_write_b32 v16, v25 offset:4608
    s_waitcnt lgkmcnt(0)
    s_barrier
    s_cmp_eq_u32 s64, 0
    s_cbranch_scc0 L_fin
    ds_read_b32 v24, v17 offset:4608
    ds_read_b32 v25, v17 offset:4864
    ds_read_b32 v26, v17 offset:5120
    ds_read_b32 v27, v17 offset:5376
    s_waitcnt lgkmcnt(0)
    v_add_f32 v24, v24, v25
    v_add_f32 v26, v26, v27
    v_add_f32 v24, v24, v26
    v_cvt_pk_bf16_f32 v24, v24, v24
    s_mov_b32 exec_lo, 0x00ff00ff
    s_mov_b32 exec_hi, 0x00ff00ff
    buffer_store_short v24, v6, s[60:63], s13 offen
    s_mov_b64 exec, -1
    s_cmp_eq_u32 s2, 0
    s_cbranch_scc0 L_fin
    v_mov_b32 v7, s69
    s_mov_b64 exec, 1
    buffer_store_dword v7, off, s[28:31], 0 offset:0 sc1
    s_mov_b64 exec, -1
L_fin:
L_end:
    s_endpgm
.section .rodata,"a"
.p2align 6
.amdhsa_kernel concat_heads__sliding_block_cached__gqa_block_cached__decode_kernel
  .amdhsa_next_free_vgpr 492
  .amdhsa_next_free_sgpr 102
  .amdhsa_accum_offset 256
  .amdhsa_group_segment_fixed_size 0
  .amdhsa_kernarg_size 104
  .amdhsa_user_sgpr_count 2
  .amdhsa_user_sgpr_kernarg_segment_ptr 1
  .amdhsa_system_sgpr_workgroup_id_x 1
.end_amdhsa_kernel
```
